```python
import torch

def _softmax(x, axis=-1):
    return torch.softmax(x, dim=axis)
def _gelu(x):
    return torch.nn.functional.gelu(x, approximate="tanh")
def _silu(x):
    return torch.nn.functional.silu(x)
def _sigmoid(x):
    return torch.sigmoid(x)
def _layernorm(x, axis=-1, eps=1e-5):
    m = x.mean(dim=axis, keepdim=True)
    v = x.var(dim=axis, keepdim=True, unbiased=False)
    return (x - m) / torch.sqrt(v + eps)
def _scatter_add(tgt, idx, src, axis=0):
    return tgt.clone().index_add_(axis, idx, src)
def _segment_sum(src, seg, n):
    out = torch.zeros((n,) + src.shape[1:], dtype=src.dtype)
    return out.index_add_(0, seg, src)
def _pad(x, pw):
    flat = tuple(v for pair in reversed(pw) for v in pair)
    return torch.nn.functional.pad(x, flat)

kernel_name = 'parallel_sum__sliding_local_dilated__glu_gated_reglu__prompt'

def setup_inputs():

    _w = (lambda a: (lambda t: t.to(torch.bfloat16) if t.is_floating_point() else t)(torch.as_tensor(a)))
    def _A_setup():
        B, S, D = 1, 2048, 640
        return {
            "x": _w((lambda *s: torch.randn(*s, dtype=torch.bfloat16) * 0.05)(B, S, D)),
            "wqkv": _w((lambda *s: torch.randn(*s, dtype=torch.bfloat16) * 0.05)(D, 3 * D)),
            "wo": _w((lambda *s: torch.randn(*s, dtype=torch.bfloat16) * 0.05)(D, D)),
        }
    _A_in = _A_setup()

    def _B_setup():
        B, S, D, F = 1, 2048, 640, 1728
        return {
            "x": _w((lambda *s: torch.randn(*s, dtype=torch.bfloat16) * 0.05)(B, S, D)),
            "W_gate": _w((lambda *s: torch.randn(*s, dtype=torch.bfloat16) * 0.8)(D, F) * (2.0 / D) ** 0.5),
            "W_up": _w((lambda *s: torch.randn(*s, dtype=torch.bfloat16) * 0.8)(D, F) * (2.0 / D) ** 0.5),
            "W_down": _w((lambda *s: torch.randn(*s, dtype=torch.bfloat16) * 0.8)(F, D) * (1.0 / F) ** 0.5),
        }
    _B_in = _B_setup()

    return {
        "A_x": _A_in["x"],
        "A_wqkv": _A_in["wqkv"],
        "A_wo": _A_in["wo"],
        "B_x": _B_in["x"],
        "B_W_gate": _B_in["W_gate"],
        "B_W_up": _B_in["W_up"],
        "B_W_down": _B_in["W_down"],
    }

def reference(A_x, A_wqkv, A_wo, B_x, B_W_gate, B_W_up, B_W_down):
    def _A_ref(x, wqkv, wo):
        B, S, D = x.shape
        H = 32; Dh = D // H
        W, dil = 8, 2
        qkv = (lambda x, *d: x.permute(*d))((x @ wqkv).reshape(B, S, 3, H, Dh), 2, 0, 3, 1, 4)
        q, k, v = qkv[0], qkv[1], qkv[2]
        scale = Dh ** -0.5
        pos = torch.arange(S)
        off = torch.arange(W) * dil
        idx = pos[:, None] - off[None, :]
        mask = idx >= 0
        idx_c = torch.where(mask, idx, 0).reshape(-1)
        kg = k[:, :, idx_c, :].reshape(B, H, S, W, Dh)
        vg = v[:, :, idx_c, :].reshape(B, H, S, W, Dh)
        logits = torch.einsum("bhsd,bhswd->bhsw", q, kg) * scale
        logits = torch.where(mask[None, None, :, :], logits, -1e9)
        attn = _softmax(logits, axis=-1)
        o = torch.einsum("bhsw,bhswd->bhsd", attn, vg)
        return (lambda x, *d: x.permute(*d))(o, 0, 2, 1, 3).reshape(B, S, D) @ wo

    def _B_ref(x, W_gate, W_up, W_down):
        gate = torch.einsum("bsd,df->bsf", x, W_gate)
        up = torch.einsum("bsd,df->bsf", x, W_up)
        gate = gate * (lambda x, dt: x.to(dt))(gate > 0, gate.dtype)
        h = gate * up
        return torch.einsum("bsf,fd->bsd", h, W_down)

    x = A_x
    xn = _layernorm(x, axis=-1)
    return x + _A_ref(xn, A_wqkv, A_wo) + _B_ref(xn, B_W_gate, B_W_up, B_W_down)
```

```asm
; @launch kernel=ln_kernel grid=(512,1,1) block=(256,1,1) lds=0
; @launch kernel=gemm1_kernel grid=(224,1,1) block=(512,1,1) lds=114816
; @launch kernel=attn_kernel grid=(256,1,1) block=(256,1,1) lds=0
; @launch kernel=gemm2_kernel grid=(256,1,1) block=(256,1,1) lds=122880
.amdgcn_target "amdgcn-amd-amdhsa--gfx950"
.text
.globl ln_kernel
.p2align 8
.type ln_kernel,@function
ln_kernel:
    s_cmp_ge_u32 s2, 512
    s_cbranch_scc1 ln_done
    s_load_dwordx2 s[4:5], s[0:1], 0
    s_load_dwordx2 s[6:7], s[0:1], 72
    v_lshrrev_b32 v1, 6, v0
    v_and_b32 v2, 63, v0
    s_lshl_b32 s3, s2, 2
    v_add_u32 v1, s3, v1
    v_mul_u32_u24 v3, 0x500, v1
    v_lshl_add_u32 v3, v2, 2, v3
    s_waitcnt lgkmcnt(0)
    s_mov_b32 s8, s4
    s_and_b32 s9, s5, 0xffff
    s_mov_b32 s10, 2621440
    s_mov_b32 s11, 0x20000
    s_mov_b32 s12, s6
    s_and_b32 s13, s7, 0xffff
    s_mov_b32 s14, 2621440
    s_mov_b32 s15, 0x20000
    buffer_load_dword v10, v3, s[8:11], 0 offen offset:0
    buffer_load_dword v11, v3, s[8:11], 0 offen offset:256
    buffer_load_dword v12, v3, s[8:11], 0 offen offset:512
    buffer_load_dword v13, v3, s[8:11], 0 offen offset:768
    buffer_load_dword v14, v3, s[8:11], 0 offen offset:1024
    s_waitcnt vmcnt(0)
    v_lshlrev_b32 v20, 16, v10
    v_and_b32 v21, 0xffff0000, v10
    v_lshlrev_b32 v22, 16, v11
    v_and_b32 v23, 0xffff0000, v11
    v_lshlrev_b32 v24, 16, v12
    v_and_b32 v25, 0xffff0000, v12
    v_lshlrev_b32 v26, 16, v13
    v_and_b32 v27, 0xffff0000, v13
    v_lshlrev_b32 v28, 16, v14
    v_and_b32 v29, 0xffff0000, v14
    v_add_f32 v30, v20, v21
    v_add_f32 v30, v30, v22
    v_add_f32 v30, v30, v23
    v_add_f32 v30, v30, v24
    v_add_f32 v30, v30, v25
    v_add_f32 v30, v30, v26
    v_add_f32 v30, v30, v27
    v_add_f32 v30, v30, v28
    v_add_f32 v30, v30, v29
    ds_swizzle_b32 v31, v30 offset:0x41f
    s_waitcnt lgkmcnt(0)
    v_add_f32 v30, v30, v31
    ds_swizzle_b32 v31, v30 offset:0x81f
    s_waitcnt lgkmcnt(0)
    v_add_f32 v30, v30, v31
    ds_swizzle_b32 v31, v30 offset:0x101f
    s_waitcnt lgkmcnt(0)
    v_add_f32 v30, v30, v31
    ds_swizzle_b32 v31, v30 offset:0x201f
    s_waitcnt lgkmcnt(0)
    v_add_f32 v30, v30, v31
    ds_swizzle_b32 v31, v30 offset:0x401f
    s_waitcnt lgkmcnt(0)
    v_add_f32 v30, v30, v31
    s_nop 1
    v_readlane_b32 s20, v30, 0
    v_readlane_b32 s21, v30, 32
    s_nop 3
    v_mov_b32 v30, s20
    v_add_f32 v30, s21, v30
    v_mul_f32 v30, 0x3acccccd, v30
    v_mov_b32 v32, 0
    v_sub_f32 v33, v20, v30
    v_fmac_f32 v32, v33, v33
    v_sub_f32 v33, v21, v30
    v_fmac_f32 v32, v33, v33
    v_sub_f32 v33, v22, v30
    v_fmac_f32 v32, v33, v33
    v_sub_f32 v33, v23, v30
    v_fmac_f32 v32, v33, v33
    v_sub_f32 v33, v24, v30
    v_fmac_f32 v32, v33, v33
    v_sub_f32 v33, v25, v30
    v_fmac_f32 v32, v33, v33
    v_sub_f32 v33, v26, v30
    v_fmac_f32 v32, v33, v33
    v_sub_f32 v33, v27, v30
    v_fmac_f32 v32, v33, v33
    v_sub_f32 v33, v28, v30
    v_fmac_f32 v32, v33, v33
    v_sub_f32 v33, v29, v30
    v_fmac_f32 v32, v33, v33
    ds_swizzle_b32 v31, v32 offset:0x41f
    s_waitcnt lgkmcnt(0)
    v_add_f32 v32, v32, v31
    ds_swizzle_b32 v31, v32 offset:0x81f
    s_waitcnt lgkmcnt(0)
    v_add_f32 v32, v32, v31
    ds_swizzle_b32 v31, v32 offset:0x101f
    s_waitcnt lgkmcnt(0)
    v_add_f32 v32, v32, v31
    ds_swizzle_b32 v31, v32 offset:0x201f
    s_waitcnt lgkmcnt(0)
    v_add_f32 v32, v32, v31
    ds_swizzle_b32 v31, v32 offset:0x401f
    s_waitcnt lgkmcnt(0)
    v_add_f32 v32, v32, v31
    s_nop 1
    v_readlane_b32 s20, v32, 0
    v_readlane_b32 s21, v32, 32
    s_nop 3
    v_mov_b32 v32, s20
    v_add_f32 v32, s21, v32
    v_mul_f32 v32, 0x3acccccd, v32
    v_cvt_pk_bf16_f32 v34, v30, v32
    s_nop 0
    v_lshlrev_b32 v30, 16, v34
    v_and_b32 v32, 0xffff0000, v34
    v_add_f32 v32, 0x3727c5ac, v32
    v_cvt_pk_bf16_f32 v32, v32, v32
    s_nop 0
    v_lshlrev_b32 v32, 16, v32
    v_sqrt_f32 v32, v32
    s_nop 1
    v_cvt_pk_bf16_f32 v32, v32, v32
    s_nop 0
    v_lshlrev_b32 v32, 16, v32
    v_rcp_f32 v35, v32
    s_nop 1
    v_sub_f32 v20, v20, v30
    v_sub_f32 v21, v21, v30
    v_sub_f32 v22, v22, v30
    v_sub_f32 v23, v23, v30
    v_sub_f32 v24, v24, v30
    v_sub_f32 v25, v25, v30
    v_sub_f32 v26, v26, v30
    v_sub_f32 v27, v27, v30
    v_sub_f32 v28, v28, v30
    v_sub_f32 v29, v29, v30
    v_cvt_pk_bf16_f32 v40, v20, v21
    v_cvt_pk_bf16_f32 v41, v22, v23
    v_cvt_pk_bf16_f32 v42, v24, v25
    v_cvt_pk_bf16_f32 v43, v26, v27
    v_cvt_pk_bf16_f32 v44, v28, v29
    s_nop 0
    v_lshlrev_b32 v20, 16, v40
    v_and_b32 v21, 0xffff0000, v40
    v_lshlrev_b32 v22, 16, v41
    v_and_b32 v23, 0xffff0000, v41
    v_lshlrev_b32 v24, 16, v42
    v_and_b32 v25, 0xffff0000, v42
    v_lshlrev_b32 v26, 16, v43
    v_and_b32 v27, 0xffff0000, v43
    v_lshlrev_b32 v28, 16, v44
    v_and_b32 v29, 0xffff0000, v44
    v_mul_f32 v20, v20, v35
    v_mul_f32 v21, v21, v35
    v_mul_f32 v22, v22, v35
    v_mul_f32 v23, v23, v35
    v_mul_f32 v24, v24, v35
    v_mul_f32 v25, v25, v35
    v_mul_f32 v26, v26, v35
    v_mul_f32 v27, v27, v35
    v_mul_f32 v28, v28, v35
    v_mul_f32 v29, v29, v35
    v_cvt_pk_bf16_f32 v40, v20, v21
    v_cvt_pk_bf16_f32 v41, v22, v23
    v_cvt_pk_bf16_f32 v42, v24, v25
    v_cvt_pk_bf16_f32 v43, v26, v27
    v_cvt_pk_bf16_f32 v44, v28, v29
    buffer_store_dword v40, v3, s[12:15], 0 offen offset:0
    buffer_store_dword v41, v3, s[12:15], 0 offen offset:256
    buffer_store_dword v42, v3, s[12:15], 0 offen offset:512
    buffer_store_dword v43, v3, s[12:15], 0 offen offset:768
    buffer_store_dword v44, v3, s[12:15], 0 offen offset:1024
    s_waitcnt vmcnt(0)
ln_done:
    s_endpgm
.globl gemm1_kernel
.p2align 8
.type gemm1_kernel,@function
gemm1_kernel:
    s_cmp_ge_u32 s2, 224
    s_cbranch_scc1 g1_done
    s_load_dwordx2 s[4:5], s[0:1], 8
    s_load_dwordx4 s[8:11], s[0:1], 32
    s_load_dwordx2 s[6:7], s[0:1], 72
    s_and_b32 s12, s2, 7
    s_lshr_b32 s13, s2, 3
    s_and_b32 s14, s12, 1
    s_lshl_b32 s14, s14, 2
    s_and_b32 s15, s13, 3
    s_add_u32 s14, s14, s15
    s_lshr_b32 s15, s12, 1
    s_mul_i32 s15, s15, 7
    s_lshr_b32 s16, s13, 2
    s_add_u32 s15, s15, s16
    v_lshrrev_b32 v1, 6, v0
    s_nop 0
    v_readfirstlane_b32 s17, v1
    v_and_b32 v2, 63, v0
    s_waitcnt lgkmcnt(0)
    s_mov_b32 s20, s6
    s_and_b32 s21, s7, 0xffff
    s_mov_b32 s22, 2621440
    s_mov_b32 s23, 0x20000
    s_cmp_ge_u32 s15, 10
    s_cbranch_scc1 g1_glu_setup
    s_mov_b32 s24, s4
    s_and_b32 s25, s5, 0xffff
    s_mov_b32 s26, 2457600
    s_mov_b32 s27, 0x20000
    s_mov_b32 s28, 3840
    s_mul_i32 s29, s15, 384
    s_and_b32 s30, s17, 1
    s_mul_i32 s30, s30, 192
    s_add_u32 s29, s29, s30
    s_branch g1_setup_done
g1_glu_setup:
    s_and_b32 s30, s17, 1
    s_cmp_eq_u32 s30, 1
    s_cselect_b32 s31, s10, s8
    s_cselect_b32 s32, s11, s9
    s_mov_b32 s24, s31
    s_and_b32 s25, s32, 0xffff
    s_mov_b32 s26, 2211840
    s_mov_b32 s27, 0x20000
    s_mov_b32 s28, 3456
    s_sub_u32 s29, s15, 10
    s_mul_i32 s29, s29, 192
g1_setup_done:
    v_add_u32 v6, 0, v2
    v_mul_u32_u24 v7, 0xaaab, v6
    v_lshrrev_b32 v7, 19, v7
    v_mul_u32_u24 v8, 12, v7
    v_sub_u32 v8, v6, v8
    v_mul_lo_u32 v7, v7, s28
    v_lshl_add_u32 v7, v8, 4, v7
    v_subrev_u32 v3, 0, v7
    v_add_u32 v6, 64, v2
    v_mul_u32_u24 v7, 0xaaab, v6
    v_lshrrev_b32 v7, 19, v7
    v_mul_u32_u24 v8, 12, v7
    v_sub_u32 v8, v6, v8
    v_mul_lo_u32 v7, v7, s28
    v_lshl_add_u32 v7, v8, 4, v7
    v_subrev_u32 v4, 1024, v7
    v_add_u32 v6, 128, v2
    v_mul_u32_u24 v7, 0xaaab, v6
    v_lshrrev_b32 v7, 19, v7
    v_mul_u32_u24 v8, 12, v7
    v_sub_u32 v8, v6, v8
    v_mul_lo_u32 v7, v7, s28
    v_lshl_add_u32 v7, v8, 4, v7
    v_subrev_u32 v5, 2048, v7
    s_lshr_b32 s34, s17, 1
    s_lshl_b32 s34, s34, 4
    s_mul_i32 s33, s34, s28
    s_add_u32 s33, s33, s29
    s_lshl_b32 s35, s28, 6
    s_and_b32 s36, s17, 1
    s_mul_i32 s36, s36, 12320
    s_mul_i32 s37, s34, 192
    s_add_u32 s36, s36, s37
    s_add_u32 s36, s36, 65536
    v_lshrrev_b32 v6, 4, v2
    v_add_u32 v6, 0, v6
    v_and_b32 v6, 7, v6
    v_and_b32 v7, 7, v2
    v_xor_b32 v7, v7, v6
    v_lshrrev_b32 v8, 3, v2
    v_mul_u32_u24 v8, 0x500, v8
    v_lshl_add_u32 v9, v7, 4, v8
    v_lshrrev_b32 v6, 4, v2
    v_add_u32 v6, 4, v6
    v_and_b32 v6, 7, v6
    v_and_b32 v7, 7, v2
    v_xor_b32 v7, v7, v6
    v_lshrrev_b32 v8, 3, v2
    v_mul_u32_u24 v8, 0x500, v8
    v_lshl_add_u32 v10, v7, 4, v8
    s_lshl_b32 s38, s14, 8
    s_lshl_b32 s39, s17, 5
    s_add_u32 s38, s38, s39
    s_mul_i32 s40, s38, 1280
    s_add_u32 s41, s40, 9216
    s_add_u32 s42, s40, 18432
    s_add_u32 s43, s40, 27648
    s_lshl_b32 s44, s17, 12
    s_lshr_b32 s45, s17, 1
    s_lshl_b32 s45, s45, 6
    v_and_b32 v6, 31, v2
    v_add_u32 v6, s45, v6
    v_lshrrev_b32 v7, 1, v6
    v_and_b32 v7, 7, v7
    v_lshrrev_b32 v8, 5, v2
    v_add_u32 v15, 0, v8
    v_xor_b32 v15, v15, v7
    v_lshlrev_b32 v15, 4, v15
    v_lshl_add_u32 v11, v6, 7, v15
    v_add_u32 v15, 2, v8
    v_xor_b32 v15, v15, v7
    v_lshlrev_b32 v15, 4, v15
    v_lshl_add_u32 v12, v6, 7, v15
    v_add_u32 v15, 4, v8
    v_xor_b32 v15, v15, v7
    v_lshlrev_b32 v15, 4, v15
    v_lshl_add_u32 v13, v6, 7, v15
    v_add_u32 v15, 6, v8
    v_xor_b32 v15, v15, v7
    v_lshlrev_b32 v15, 4, v15
    v_lshl_add_u32 v14, v6, 7, v15
    v_lshrrev_b32 v6, 4, v2
    v_and_b32 v7, 1, v6
    v_mul_u32_u24 v7, 12320, v7
    v_lshrrev_b32 v8, 1, v6
    v_lshlrev_b32 v8, 3, v8
    v_and_b32 v16, 15, v2
    v_lshrrev_b32 v17, 2, v16
    v_add_u32 v8, v8, v17
    v_mul_u32_u24 v8, 192, v8
    v_add_u32 v7, v7, v8
    v_and_b32 v16, 3, v16
    v_lshl_add_u32 v7, v16, 3, v7
    s_and_b32 s46, s17, 1
    s_mul_i32 s46, s46, 96
    s_add_u32 s46, s46, 65536
    v_add_u32 v15, s46, v7
    v_mov_b32 v100, 0
    v_mov_b32 v101, 0
    v_mov_b32 v102, 0
    v_mov_b32 v103, 0
    v_mov_b32 v104, 0
    v_mov_b32 v105, 0
    v_mov_b32 v106, 0
    v_mov_b32 v107, 0
    v_mov_b32 v108, 0
    v_mov_b32 v109, 0
    v_mov_b32 v110, 0
    v_mov_b32 v111, 0
    v_mov_b32 v112, 0
    v_mov_b32 v113, 0
    v_mov_b32 v114, 0
    v_mov_b32 v115, 0
    v_mov_b32 v116, 0
    v_mov_b32 v117, 0
    v_mov_b32 v118, 0
    v_mov_b32 v119, 0
    v_mov_b32 v120, 0
    v_mov_b32 v121, 0
    v_mov_b32 v122, 0
    v_mov_b32 v123, 0
    v_mov_b32 v124, 0
    v_mov_b32 v125, 0
    v_mov_b32 v126, 0
    v_mov_b32 v127, 0
    v_mov_b32 v128, 0
    v_mov_b32 v129, 0
    v_mov_b32 v130, 0
    v_mov_b32 v131, 0
    v_mov_b32 v132, 0
    v_mov_b32 v133, 0
    v_mov_b32 v134, 0
    v_mov_b32 v135, 0
    v_mov_b32 v136, 0
    v_mov_b32 v137, 0
    v_mov_b32 v138, 0
    v_mov_b32 v139, 0
    v_mov_b32 v140, 0
    v_mov_b32 v141, 0
    v_mov_b32 v142, 0
    v_mov_b32 v143, 0
    v_mov_b32 v144, 0
    v_mov_b32 v145, 0
    v_mov_b32 v146, 0
    v_mov_b32 v147, 0
    v_mov_b32 v148, 0
    v_mov_b32 v149, 0
    v_mov_b32 v150, 0
    v_mov_b32 v151, 0
    v_mov_b32 v152, 0
    v_mov_b32 v153, 0
    v_mov_b32 v154, 0
    v_mov_b32 v155, 0
    v_mov_b32 v156, 0
    v_mov_b32 v157, 0
    v_mov_b32 v158, 0
    v_mov_b32 v159, 0
    v_mov_b32 v160, 0
    v_mov_b32 v161, 0
    v_mov_b32 v162, 0
    v_mov_b32 v163, 0
    v_mov_b32 v164, 0
    v_mov_b32 v165, 0
    v_mov_b32 v166, 0
    v_mov_b32 v167, 0
    v_mov_b32 v168, 0
    v_mov_b32 v169, 0
    v_mov_b32 v170, 0
    v_mov_b32 v171, 0
    v_mov_b32 v172, 0
    v_mov_b32 v173, 0
    v_mov_b32 v174, 0
    v_mov_b32 v175, 0
    v_mov_b32 v176, 0
    v_mov_b32 v177, 0
    v_mov_b32 v178, 0
    v_mov_b32 v179, 0
    v_mov_b32 v180, 0
    v_mov_b32 v181, 0
    v_mov_b32 v182, 0
    v_mov_b32 v183, 0
    v_mov_b32 v184, 0
    v_mov_b32 v185, 0
    v_mov_b32 v186, 0
    v_mov_b32 v187, 0
    v_mov_b32 v188, 0
    v_mov_b32 v189, 0
    v_mov_b32 v190, 0
    v_mov_b32 v191, 0
    v_mov_b32 v192, 0
    v_mov_b32 v193, 0
    v_mov_b32 v194, 0
    v_mov_b32 v195, 0
    s_add_u32 m0, s44, 0
    s_nop 0
    buffer_load_dwordx4 v9, s[20:23], s40 offen offset:0 lds
    buffer_load_dwordx4 v10, s[20:23], s41 offen offset:1024 lds
    buffer_load_dwordx4 v9, s[20:23], s42 offen offset:2048 lds
    buffer_load_dwordx4 v10, s[20:23], s43 offen offset:3072 lds
    s_add_u32 m0, s36, 0
    s_nop 0
    buffer_load_dwordx4 v3, s[24:27], s33 offen offset:0 lds
    buffer_load_dwordx4 v4, s[24:27], s33 offen offset:1024 lds
    buffer_load_dwordx4 v5, s[24:27], s33 offen offset:2048 lds
    s_add_u32 s40, s40, 128
    s_add_u32 s41, s41, 128
    s_add_u32 s42, s42, 128
    s_add_u32 s43, s43, 128
    s_add_u32 s33, s33, s35
    s_waitcnt vmcnt(0)
    s_barrier
    ds_read_b128 v[40:43], v11 offset:0
    ds_read_b128 v[44:47], v11 offset:4096
    ds_read_b64_tr_b16 v[56:57], v15 offset:0
    ds_read_b64_tr_b16 v[58:59], v15 offset:768
    ds_read_b64_tr_b16 v[60:61], v15 offset:32
    ds_read_b64_tr_b16 v[62:63], v15 offset:800
    ds_read_b64_tr_b16 v[64:65], v15 offset:64
    ds_read_b64_tr_b16 v[66:67], v15 offset:832
    s_add_u32 m0, s44, 32768
    s_nop 0
    buffer_load_dwordx4 v9, s[20:23], s40 offen offset:0 lds
    buffer_load_dwordx4 v10, s[20:23], s41 offen offset:1024 lds
    buffer_load_dwordx4 v9, s[20:23], s42 offen offset:2048 lds
    buffer_load_dwordx4 v10, s[20:23], s43 offen offset:3072 lds
    s_add_u32 m0, s36, 24640
    s_nop 0
    buffer_load_dwordx4 v3, s[24:27], s33 offen offset:0 lds
    buffer_load_dwordx4 v4, s[24:27], s33 offen offset:1024 lds
    buffer_load_dwordx4 v5, s[24:27], s33 offen offset:2048 lds
    s_add_u32 s40, s40, 128
    s_add_u32 s41, s41, 128
    s_add_u32 s42, s42, 128
    s_add_u32 s43, s43, 128
    s_add_u32 s33, s33, s35
    ds_read_b128 v[48:51], v12 offset:0
    ds_read_b128 v[52:55], v12 offset:4096
    ds_read_b64_tr_b16 v[68:69], v15 offset:3072
    ds_read_b64_tr_b16 v[70:71], v15 offset:3840
    ds_read_b64_tr_b16 v[72:73], v15 offset:3104
    ds_read_b64_tr_b16 v[74:75], v15 offset:3872
    ds_read_b64_tr_b16 v[76:77], v15 offset:3136
    ds_read_b64_tr_b16 v[78:79], v15 offset:3904
    s_waitcnt lgkmcnt(8)
    v_mfma_f32_32x32x16_bf16 v[100:115], v[56:59], v[40:43], v[100:115]
    v_mfma_f32_32x32x16_bf16 v[116:131], v[56:59], v[44:47], v[116:131]
    v_mfma_f32_32x32x16_bf16 v[132:147], v[60:63], v[40:43], v[132:147]
    v_mfma_f32_32x32x16_bf16 v[148:163], v[60:63], v[44:47], v[148:163]
    v_mfma_f32_32x32x16_bf16 v[164:179], v[64:67], v[40:43], v[164:179]
    v_mfma_f32_32x32x16_bf16 v[180:195], v[64:67], v[44:47], v[180:195]
    ds_read_b128 v[40:43], v13 offset:0
    ds_read_b128 v[44:47], v13 offset:4096
    ds_read_b64_tr_b16 v[56:57], v15 offset:6144
    ds_read_b64_tr_b16 v[58:59], v15 offset:6912
    ds_read_b64_tr_b16 v[60:61], v15 offset:6176
    ds_read_b64_tr_b16 v[62:63], v15 offset:6944
    ds_read_b64_tr_b16 v[64:65], v15 offset:6208
    ds_read_b64_tr_b16 v[66:67], v15 offset:6976
    s_waitcnt lgkmcnt(8)
    v_mfma_f32_32x32x16_bf16 v[100:115], v[68:71], v[48:51], v[100:115]
    v_mfma_f32_32x32x16_bf16 v[116:131], v[68:71], v[52:55], v[116:131]
    v_mfma_f32_32x32x16_bf16 v[132:147], v[72:75], v[48:51], v[132:147]
    v_mfma_f32_32x32x16_bf16 v[148:163], v[72:75], v[52:55], v[148:163]
    v_mfma_f32_32x32x16_bf16 v[164:179], v[76:79], v[48:51], v[164:179]
    v_mfma_f32_32x32x16_bf16 v[180:195], v[76:79], v[52:55], v[180:195]
    ds_read_b128 v[48:51], v14 offset:0
    ds_read_b128 v[52:55], v14 offset:4096
    ds_read_b64_tr_b16 v[68:69], v15 offset:9216
    ds_read_b64_tr_b16 v[70:71], v15 offset:9984
    ds_read_b64_tr_b16 v[72:73], v15 offset:9248
    ds_read_b64_tr_b16 v[74:75], v15 offset:10016
    ds_read_b64_tr_b16 v[76:77], v15 offset:9280
    ds_read_b64_tr_b16 v[78:79], v15 offset:10048
    s_waitcnt lgkmcnt(8)
    v_mfma_f32_32x32x16_bf16 v[100:115], v[56:59], v[40:43], v[100:115]
    v_mfma_f32_32x32x16_bf16 v[116:131], v[56:59], v[44:47], v[116:131]
    v_mfma_f32_32x32x16_bf16 v[132:147], v[60:63], v[40:43], v[132:147]
    v_mfma_f32_32x32x16_bf16 v[148:163], v[60:63], v[44:47], v[148:163]
    v_mfma_f32_32x32x16_bf16 v[164:179], v[64:67], v[40:43], v[164:179]
    v_mfma_f32_32x32x16_bf16 v[180:195], v[64:67], v[44:47], v[180:195]
    s_waitcnt lgkmcnt(0)
    v_mfma_f32_32x32x16_bf16 v[100:115], v[68:71], v[48:51], v[100:115]
    v_mfma_f32_32x32x16_bf16 v[116:131], v[68:71], v[52:55], v[116:131]
    v_mfma_f32_32x32x16_bf16 v[132:147], v[72:75], v[48:51], v[132:147]
    v_mfma_f32_32x32x16_bf16 v[148:163], v[72:75], v[52:55], v[148:163]
    v_mfma_f32_32x32x16_bf16 v[164:179], v[76:79], v[48:51], v[164:179]
    v_mfma_f32_32x32x16_bf16 v[180:195], v[76:79], v[52:55], v[180:195]
    s_waitcnt vmcnt(0)
    s_barrier
    ds_read_b128 v[40:43], v11 offset:32768
    ds_read_b128 v[44:47], v11 offset:36864
    ds_read_b64_tr_b16 v[56:57], v15 offset:24640
    ds_read_b64_tr_b16 v[58:59], v15 offset:25408
    ds_read_b64_tr_b16 v[60:61], v15 offset:24672
    ds_read_b64_tr_b16 v[62:63], v15 offset:25440
    ds_read_b64_tr_b16 v[64:65], v15 offset:24704
    ds_read_b64_tr_b16 v[66:67], v15 offset:25472
    s_add_u32 m0, s44, 0
    s_nop 0
    buffer_load_dwordx4 v9, s[20:23], s40 offen offset:0 lds
    buffer_load_dwordx4 v10, s[20:23], s41 offen offset:1024 lds
    buffer_load_dwordx4 v9, s[20:23], s42 offen offset:2048 lds
    buffer_load_dwordx4 v10, s[20:23], s43 offen offset:3072 lds
    s_add_u32 m0, s36, 0
    s_nop 0
    buffer_load_dwordx4 v3, s[24:27], s33 offen offset:0 lds
    buffer_load_dwordx4 v4, s[24:27], s33 offen offset:1024 lds
    buffer_load_dwordx4 v5, s[24:27], s33 offen offset:2048 lds
    s_add_u32 s40, s40, 128
    s_add_u32 s41, s41, 128
    s_add_u32 s42, s42, 128
    s_add_u32 s43, s43, 128
    s_add_u32 s33, s33, s35
    ds_read_b128 v[48:51], v12 offset:32768
    ds_read_b128 v[52:55], v12 offset:36864
    ds_read_b64_tr_b16 v[68:69], v15 offset:27712
    ds_read_b64_tr_b16 v[70:71], v15 offset:28480
    ds_read_b64_tr_b16 v[72:73], v15 offset:27744
    ds_read_b64_tr_b16 v[74:75], v15 offset:28512
    ds_read_b64_tr_b16 v[76:77], v15 offset:27776
    ds_read_b64_tr_b16 v[78:79], v15 offset:28544
    s_waitcnt lgkmcnt(8)
    v_mfma_f32_32x32x16_bf16 v[100:115], v[56:59], v[40:43], v[100:115]
    v_mfma_f32_32x32x16_bf16 v[116:131], v[56:59], v[44:47], v[116:131]
    v_mfma_f32_32x32x16_bf16 v[132:147], v[60:63], v[40:43], v[132:147]
    v_mfma_f32_32x32x16_bf16 v[148:163], v[60:63], v[44:47], v[148:163]
    v_mfma_f32_32x32x16_bf16 v[164:179], v[64:67], v[40:43], v[164:179]
    v_mfma_f32_32x32x16_bf16 v[180:195], v[64:67], v[44:47], v[180:195]
    ds_read_b128 v[40:43], v13 offset:32768
    ds_read_b128 v[44:47], v13 offset:36864
    ds_read_b64_tr_b16 v[56:57], v15 offset:30784
    ds_read_b64_tr_b16 v[58:59], v15 offset:31552
    ds_read_b64_tr_b16 v[60:61], v15 offset:30816
    ds_read_b64_tr_b16 v[62:63], v15 offset:31584
    ds_read_b64_tr_b16 v[64:65], v15 offset:30848
    ds_read_b64_tr_b16 v[66:67], v15 offset:31616
    s_waitcnt lgkmcnt(8)
    v_mfma_f32_32x32x16_bf16 v[100:115], v[68:71], v[48:51], v[100:115]
    v_mfma_f32_32x32x16_bf16 v[116:131], v[68:71], v[52:55], v[116:131]
    v_mfma_f32_32x32x16_bf16 v[132:147], v[72:75], v[48:51], v[132:147]
    v_mfma_f32_32x32x16_bf16 v[148:163], v[72:75], v[52:55], v[148:163]
    v_mfma_f32_32x32x16_bf16 v[164:179], v[76:79], v[48:51], v[164:179]
    v_mfma_f32_32x32x16_bf16 v[180:195], v[76:79], v[52:55], v[180:195]
    ds_read_b128 v[48:51], v14 offset:32768
    ds_read_b128 v[52:55], v14 offset:36864
    ds_read_b64_tr_b16 v[68:69], v15 offset:33856
    ds_read_b64_tr_b16 v[70:71], v15 offset:34624
    ds_read_b64_tr_b16 v[72:73], v15 offset:33888
    ds_read_b64_tr_b16 v[74:75], v15 offset:34656
    ds_read_b64_tr_b16 v[76:77], v15 offset:33920
    ds_read_b64_tr_b16 v[78:79], v15 offset:34688
    s_waitcnt lgkmcnt(8)
    v_mfma_f32_32x32x16_bf16 v[100:115], v[56:59], v[40:43], v[100:115]
    v_mfma_f32_32x32x16_bf16 v[116:131], v[56:59], v[44:47], v[116:131]
    v_mfma_f32_32x32x16_bf16 v[132:147], v[60:63], v[40:43], v[132:147]
    v_mfma_f32_32x32x16_bf16 v[148:163], v[60:63], v[44:47], v[148:163]
    v_mfma_f32_32x32x16_bf16 v[164:179], v[64:67], v[40:43], v[164:179]
    v_mfma_f32_32x32x16_bf16 v[180:195], v[64:67], v[44:47], v[180:195]
    s_waitcnt lgkmcnt(0)
    v_mfma_f32_32x32x16_bf16 v[100:115], v[68:71], v[48:51], v[100:115]
    v_mfma_f32_32x32x16_bf16 v[116:131], v[68:71], v[52:55], v[116:131]
    v_mfma_f32_32x32x16_bf16 v[132:147], v[72:75], v[48:51], v[132:147]
    v_mfma_f32_32x32x16_bf16 v[148:163], v[72:75], v[52:55], v[148:163]
    v_mfma_f32_32x32x16_bf16 v[164:179], v[76:79], v[48:51], v[164:179]
    v_mfma_f32_32x32x16_bf16 v[180:195], v[76:79], v[52:55], v[180:195]
    s_waitcnt vmcnt(0)
    s_barrier
    ds_read_b128 v[40:43], v11 offset:0
    ds_read_b128 v[44:47], v11 offset:4096
    ds_read_b64_tr_b16 v[56:57], v15 offset:0
    ds_read_b64_tr_b16 v[58:59], v15 offset:768
    ds_read_b64_tr_b16 v[60:61], v15 offset:32
    ds_read_b64_tr_b16 v[62:63], v15 offset:800
    ds_read_b64_tr_b16 v[64:65], v15 offset:64
    ds_read_b64_tr_b16 v[66:67], v15 offset:832
    s_add_u32 m0, s44, 32768
    s_nop 0
    buffer_load_dwordx4 v9, s[20:23], s40 offen offset:0 lds
    buffer_load_dwordx4 v10, s[20:23], s41 offen offset:1024 lds
    buffer_load_dwordx4 v9, s[20:23], s42 offen offset:2048 lds
    buffer_load_dwordx4 v10, s[20:23], s43 offen offset:3072 lds
    s_add_u32 m0, s36, 24640
    s_nop 0
    buffer_load_dwordx4 v3, s[24:27], s33 offen offset:0 lds
    buffer_load_dwordx4 v4, s[24:27], s33 offen offset:1024 lds
    buffer_load_dwordx4 v5, s[24:27], s33 offen offset:2048 lds
    s_add_u32 s40, s40, 128
    s_add_u32 s41, s41, 128
    s_add_u32 s42, s42, 128
    s_add_u32 s43, s43, 128
    s_add_u32 s33, s33, s35
    ds_read_b128 v[48:51], v12 offset:0
    ds_read_b128 v[52:55], v12 offset:4096
    ds_read_b64_tr_b16 v[68:69], v15 offset:3072
    ds_read_b64_tr_b16 v[70:71], v15 offset:3840
    ds_read_b64_tr_b16 v[72:73], v15 offset:3104
    ds_read_b64_tr_b16 v[74:75], v15 offset:3872
    ds_read_b64_tr_b16 v[76:77], v15 offset:3136
    ds_read_b64_tr_b16 v[78:79], v15 offset:3904
    s_waitcnt lgkmcnt(8)
    v_mfma_f32_32x32x16_bf16 v[100:115], v[56:59], v[40:43], v[100:115]
    v_mfma_f32_32x32x16_bf16 v[116:131], v[56:59], v[44:47], v[116:131]
    v_mfma_f32_32x32x16_bf16 v[132:147], v[60:63], v[40:43], v[132:147]
    v_mfma_f32_32x32x16_bf16 v[148:163], v[60:63], v[44:47], v[148:163]
    v_mfma_f32_32x32x16_bf16 v[164:179], v[64:67], v[40:43], v[164:179]
    v_mfma_f32_32x32x16_bf16 v[180:195], v[64:67], v[44:47], v[180:195]
    ds_read_b128 v[40:43], v13 offset:0
    ds_read_b128 v[44:47], v13 offset:4096
    ds_read_b64_tr_b16 v[56:57], v15 offset:6144
    ds_read_b64_tr_b16 v[58:59], v15 offset:6912
    ds_read_b64_tr_b16 v[60:61], v15 offset:6176
    ds_read_b64_tr_b16 v[62:63], v15 offset:6944
    ds_read_b64_tr_b16 v[64:65], v15 offset:6208
    ds_read_b64_tr_b16 v[66:67], v15 offset:6976
    s_waitcnt lgkmcnt(8)
    v_mfma_f32_32x32x16_bf16 v[100:115], v[68:71], v[48:51], v[100:115]
    v_mfma_f32_32x32x16_bf16 v[116:131], v[68:71], v[52:55], v[116:131]
    v_mfma_f32_32x32x16_bf16 v[132:147], v[72:75], v[48:51], v[132:147]
    v_mfma_f32_32x32x16_bf16 v[148:163], v[72:75], v[52:55], v[148:163]
    v_mfma_f32_32x32x16_bf16 v[164:179], v[76:79], v[48:51], v[164:179]
    v_mfma_f32_32x32x16_bf16 v[180:195], v[76:79], v[52:55], v[180:195]
    ds_read_b128 v[48:51], v14 offset:0
    ds_read_b128 v[52:55], v14 offset:4096
    ds_read_b64_tr_b16 v[68:69], v15 offset:9216
    ds_read_b64_tr_b16 v[70:71], v15 offset:9984
    ds_read_b64_tr_b16 v[72:73], v15 offset:9248
    ds_read_b64_tr_b16 v[74:75], v15 offset:10016
    ds_read_b64_tr_b16 v[76:77], v15 offset:9280
    ds_read_b64_tr_b16 v[78:79], v15 offset:10048
    s_waitcnt lgkmcnt(8)
    v_mfma_f32_32x32x16_bf16 v[100:115], v[56:59], v[40:43], v[100:115]
    v_mfma_f32_32x32x16_bf16 v[116:131], v[56:59], v[44:47], v[116:131]
    v_mfma_f32_32x32x16_bf16 v[132:147], v[60:63], v[40:43], v[132:147]
    v_mfma_f32_32x32x16_bf16 v[148:163], v[60:63], v[44:47], v[148:163]
    v_mfma_f32_32x32x16_bf16 v[164:179], v[64:67], v[40:43], v[164:179]
    v_mfma_f32_32x32x16_bf16 v[180:195], v[64:67], v[44:47], v[180:195]
    s_waitcnt lgkmcnt(0)
    v_mfma_f32_32x32x16_bf16 v[100:115], v[68:71], v[48:51], v[100:115]
    v_mfma_f32_32x32x16_bf16 v[116:131], v[68:71], v[52:55], v[116:131]
    v_mfma_f32_32x32x16_bf16 v[132:147], v[72:75], v[48:51], v[132:147]
    v_mfma_f32_32x32x16_bf16 v[148:163], v[72:75], v[52:55], v[148:163]
    v_mfma_f32_32x32x16_bf16 v[164:179], v[76:79], v[48:51], v[164:179]
    v_mfma_f32_32x32x16_bf16 v[180:195], v[76:79], v[52:55], v[180:195]
    s_waitcnt vmcnt(0)
    s_barrier
    ds_read_b128 v[40:43], v11 offset:32768
    ds_read_b128 v[44:47], v11 offset:36864
    ds_read_b64_tr_b16 v[56:57], v15 offset:24640
    ds_read_b64_tr_b16 v[58:59], v15 offset:25408
    ds_read_b64_tr_b16 v[60:61], v15 offset:24672
    ds_read_b64_tr_b16 v[62:63], v15 offset:25440
    ds_read_b64_tr_b16 v[64:65], v15 offset:24704
    ds_read_b64_tr_b16 v[66:67], v15 offset:25472
    s_add_u32 m0, s44, 0
    s_nop 0
    buffer_load_dwordx4 v9, s[20:23], s40 offen offset:0 lds
    buffer_load_dwordx4 v10, s[20:23], s41 offen offset:1024 lds
    buffer_load_dwordx4 v9, s[20:23], s42 offen offset:2048 lds
    buffer_load_dwordx4 v10, s[20:23], s43 offen offset:3072 lds
    s_add_u32 m0, s36, 0
    s_nop 0
    buffer_load_dwordx4 v3, s[24:27], s33 offen offset:0 lds
    buffer_load_dwordx4 v4, s[24:27], s33 offen offset:1024 lds
    buffer_load_dwordx4 v5, s[24:27], s33 offen offset:2048 lds
    s_add_u32 s40, s40, 128
    s_add_u32 s41, s41, 128
    s_add_u32 s42, s42, 128
    s_add_u32 s43, s43, 128
    s_add_u32 s33, s33, s35
    ds_read_b128 v[48:51], v12 offset:32768
    ds_read_b128 v[52:55], v12 offset:36864
    ds_read_b64_tr_b16 v[68:69], v15 offset:27712
    ds_read_b64_tr_b16 v[70:71], v15 offset:28480
    ds_read_b64_tr_b16 v[72:73], v15 offset:27744
    ds_read_b64_tr_b16 v[74:75], v15 offset:28512
    ds_read_b64_tr_b16 v[76:77], v15 offset:27776
    ds_read_b64_tr_b16 v[78:79], v15 offset:28544
    s_waitcnt lgkmcnt(8)
    v_mfma_f32_32x32x16_bf16 v[100:115], v[56:59], v[40:43], v[100:115]
    v_mfma_f32_32x32x16_bf16 v[116:131], v[56:59], v[44:47], v[116:131]
    v_mfma_f32_32x32x16_bf16 v[132:147], v[60:63], v[40:43], v[132:147]
    v_mfma_f32_32x32x16_bf16 v[148:163], v[60:63], v[44:47], v[148:163]
    v_mfma_f32_32x32x16_bf16 v[164:179], v[64:67], v[40:43], v[164:179]
    v_mfma_f32_32x32x16_bf16 v[180:195], v[64:67], v[44:47], v[180:195]
    ds_read_b128 v[40:43], v13 offset:32768
    ds_read_b128 v[44:47], v13 offset:36864
    ds_read_b64_tr_b16 v[56:57], v15 offset:30784
    ds_read_b64_tr_b16 v[58:59], v15 offset:31552
    ds_read_b64_tr_b16 v[60:61], v15 offset:30816
    ds_read_b64_tr_b16 v[62:63], v15 offset:31584
    ds_read_b64_tr_b16 v[64:65], v15 offset:30848
    ds_read_b64_tr_b16 v[66:67], v15 offset:31616
    s_waitcnt lgkmcnt(8)
    v_mfma_f32_32x32x16_bf16 v[100:115], v[68:71], v[48:51], v[100:115]
    v_mfma_f32_32x32x16_bf16 v[116:131], v[68:71], v[52:55], v[116:131]
    v_mfma_f32_32x32x16_bf16 v[132:147], v[72:75], v[48:51], v[132:147]
    v_mfma_f32_32x32x16_bf16 v[148:163], v[72:75], v[52:55], v[148:163]
    v_mfma_f32_32x32x16_bf16 v[164:179], v[76:79], v[48:51], v[164:179]
    v_mfma_f32_32x32x16_bf16 v[180:195], v[76:79], v[52:55], v[180:195]
    ds_read_b128 v[48:51], v14 offset:32768
    ds_read_b128 v[52:55], v14 offset:36864
    ds_read_b64_tr_b16 v[68:69], v15 offset:33856
    ds_read_b64_tr_b16 v[70:71], v15 offset:34624
    ds_read_b64_tr_b16 v[72:73], v15 offset:33888
    ds_read_b64_tr_b16 v[74:75], v15 offset:34656
    ds_read_b64_tr_b16 v[76:77], v15 offset:33920
    ds_read_b64_tr_b16 v[78:79], v15 offset:34688
    s_waitcnt lgkmcnt(8)
    v_mfma_f32_32x32x16_bf16 v[100:115], v[56:59], v[40:43], v[100:115]
    v_mfma_f32_32x32x16_bf16 v[116:131], v[56:59], v[44:47], v[116:131]
    v_mfma_f32_32x32x16_bf16 v[132:147], v[60:63], v[40:43], v[132:147]
    v_mfma_f32_32x32x16_bf16 v[148:163], v[60:63], v[44:47], v[148:163]
    v_mfma_f32_32x32x16_bf16 v[164:179], v[64:67], v[40:43], v[164:179]
    v_mfma_f32_32x32x16_bf16 v[180:195], v[64:67], v[44:47], v[180:195]
    s_waitcnt lgkmcnt(0)
    v_mfma_f32_32x32x16_bf16 v[100:115], v[68:71], v[48:51], v[100:115]
    v_mfma_f32_32x32x16_bf16 v[116:131], v[68:71], v[52:55], v[116:131]
    v_mfma_f32_32x32x16_bf16 v[132:147], v[72:75], v[48:51], v[132:147]
    v_mfma_f32_32x32x16_bf16 v[148:163], v[72:75], v[52:55], v[148:163]
    v_mfma_f32_32x32x16_bf16 v[164:179], v[76:79], v[48:51], v[164:179]
    v_mfma_f32_32x32x16_bf16 v[180:195], v[76:79], v[52:55], v[180:195]
    s_waitcnt vmcnt(0)
    s_barrier
    ds_read_b128 v[40:43], v11 offset:0
    ds_read_b128 v[44:47], v11 offset:4096
    ds_read_b64_tr_b16 v[56:57], v15 offset:0
    ds_read_b64_tr_b16 v[58:59], v15 offset:768
    ds_read_b64_tr_b16 v[60:61], v15 offset:32
    ds_read_b64_tr_b16 v[62:63], v15 offset:800
    ds_read_b64_tr_b16 v[64:65], v15 offset:64
    ds_read_b64_tr_b16 v[66:67], v15 offset:832
    s_add_u32 m0, s44, 32768
    s_nop 0
    buffer_load_dwordx4 v9, s[20:23], s40 offen offset:0 lds
    buffer_load_dwordx4 v10, s[20:23], s41 offen offset:1024 lds
    buffer_load_dwordx4 v9, s[20:23], s42 offen offset:2048 lds
    buffer_load_dwordx4 v10, s[20:23], s43 offen offset:3072 lds
    s_add_u32 m0, s36, 24640
    s_nop 0
    buffer_load_dwordx4 v3, s[24:27], s33 offen offset:0 lds
    buffer_load_dwordx4 v4, s[24:27], s33 offen offset:1024 lds
    buffer_load_dwordx4 v5, s[24:27], s33 offen offset:2048 lds
    s_add_u32 s40, s40, 128
    s_add_u32 s41, s41, 128
    s_add_u32 s42, s42, 128
    s_add_u32 s43, s43, 128
    s_add_u32 s33, s33, s35
    ds_read_b128 v[48:51], v12 offset:0
    ds_read_b128 v[52:55], v12 offset:4096
    ds_read_b64_tr_b16 v[68:69], v15 offset:3072
    ds_read_b64_tr_b16 v[70:71], v15 offset:3840
    ds_read_b64_tr_b16 v[72:73], v15 offset:3104
    ds_read_b64_tr_b16 v[74:75], v15 offset:3872
    ds_read_b64_tr_b16 v[76:77], v15 offset:3136
    ds_read_b64_tr_b16 v[78:79], v15 offset:3904
    s_waitcnt lgkmcnt(8)
    v_mfma_f32_32x32x16_bf16 v[100:115], v[56:59], v[40:43], v[100:115]
    v_mfma_f32_32x32x16_bf16 v[116:131], v[56:59], v[44:47], v[116:131]
    v_mfma_f32_32x32x16_bf16 v[132:147], v[60:63], v[40:43], v[132:147]
    v_mfma_f32_32x32x16_bf16 v[148:163], v[60:63], v[44:47], v[148:163]
    v_mfma_f32_32x32x16_bf16 v[164:179], v[64:67], v[40:43], v[164:179]
    v_mfma_f32_32x32x16_bf16 v[180:195], v[64:67], v[44:47], v[180:195]
    ds_read_b128 v[40:43], v13 offset:0
    ds_read_b128 v[44:47], v13 offset:4096
    ds_read_b64_tr_b16 v[56:57], v15 offset:6144
    ds_read_b64_tr_b16 v[58:59], v15 offset:6912
    ds_read_b64_tr_b16 v[60:61], v15 offset:6176
    ds_read_b64_tr_b16 v[62:63], v15 offset:6944
    ds_read_b64_tr_b16 v[64:65], v15 offset:6208
    ds_read_b64_tr_b16 v[66:67], v15 offset:6976
    s_waitcnt lgkmcnt(8)
    v_mfma_f32_32x32x16_bf16 v[100:115], v[68:71], v[48:51], v[100:115]
    v_mfma_f32_32x32x16_bf16 v[116:131], v[68:71], v[52:55], v[116:131]
    v_mfma_f32_32x32x16_bf16 v[132:147], v[72:75], v[48:51], v[132:147]
    v_mfma_f32_32x32x16_bf16 v[148:163], v[72:75], v[52:55], v[148:163]
    v_mfma_f32_32x32x16_bf16 v[164:179], v[76:79], v[48:51], v[164:179]
    v_mfma_f32_32x32x16_bf16 v[180:195], v[76:79], v[52:55], v[180:195]
    ds_read_b128 v[48:51], v14 offset:0
    ds_read_b128 v[52:55], v14 offset:4096
    ds_read_b64_tr_b16 v[68:69], v15 offset:9216
    ds_read_b64_tr_b16 v[70:71], v15 offset:9984
    ds_read_b64_tr_b16 v[72:73], v15 offset:9248
    ds_read_b64_tr_b16 v[74:75], v15 offset:10016
    ds_read_b64_tr_b16 v[76:77], v15 offset:9280
    ds_read_b64_tr_b16 v[78:79], v15 offset:10048
    s_waitcnt lgkmcnt(8)
    v_mfma_f32_32x32x16_bf16 v[100:115], v[56:59], v[40:43], v[100:115]
    v_mfma_f32_32x32x16_bf16 v[116:131], v[56:59], v[44:47], v[116:131]
    v_mfma_f32_32x32x16_bf16 v[132:147], v[60:63], v[40:43], v[132:147]
    v_mfma_f32_32x32x16_bf16 v[148:163], v[60:63], v[44:47], v[148:163]
    v_mfma_f32_32x32x16_bf16 v[164:179], v[64:67], v[40:43], v[164:179]
    v_mfma_f32_32x32x16_bf16 v[180:195], v[64:67], v[44:47], v[180:195]
    s_waitcnt lgkmcnt(0)
    v_mfma_f32_32x32x16_bf16 v[100:115], v[68:71], v[48:51], v[100:115]
    v_mfma_f32_32x32x16_bf16 v[116:131], v[68:71], v[52:55], v[116:131]
    v_mfma_f32_32x32x16_bf16 v[132:147], v[72:75], v[48:51], v[132:147]
    v_mfma_f32_32x32x16_bf16 v[148:163], v[72:75], v[52:55], v[148:163]
    v_mfma_f32_32x32x16_bf16 v[164:179], v[76:79], v[48:51], v[164:179]
    v_mfma_f32_32x32x16_bf16 v[180:195], v[76:79], v[52:55], v[180:195]
    s_waitcnt vmcnt(0)
    s_barrier
    ds_read_b128 v[40:43], v11 offset:32768
    ds_read_b128 v[44:47], v11 offset:36864
    ds_read_b64_tr_b16 v[56:57], v15 offset:24640
    ds_read_b64_tr_b16 v[58:59], v15 offset:25408
    ds_read_b64_tr_b16 v[60:61], v15 offset:24672
    ds_read_b64_tr_b16 v[62:63], v15 offset:25440
    ds_read_b64_tr_b16 v[64:65], v15 offset:24704
    ds_read_b64_tr_b16 v[66:67], v15 offset:25472
    s_add_u32 m0, s44, 0
    s_nop 0
    buffer_load_dwordx4 v9, s[20:23], s40 offen offset:0 lds
    buffer_load_dwordx4 v10, s[20:23], s41 offen offset:1024 lds
    buffer_load_dwordx4 v9, s[20:23], s42 offen offset:2048 lds
    buffer_load_dwordx4 v10, s[20:23], s43 offen offset:3072 lds
    s_add_u32 m0, s36, 0
    s_nop 0
    buffer_load_dwordx4 v3, s[24:27], s33 offen offset:0 lds
    buffer_load_dwordx4 v4, s[24:27], s33 offen offset:1024 lds
    buffer_load_dwordx4 v5, s[24:27], s33 offen offset:2048 lds
    s_add_u32 s40, s40, 128
    s_add_u32 s41, s41, 128
    s_add_u32 s42, s42, 128
    s_add_u32 s43, s43, 128
    s_add_u32 s33, s33, s35
    ds_read_b128 v[48:51], v12 offset:32768
    ds_read_b128 v[52:55], v12 offset:36864
    ds_read_b64_tr_b16 v[68:69], v15 offset:27712
    ds_read_b64_tr_b16 v[70:71], v15 offset:28480
    ds_read_b64_tr_b16 v[72:73], v15 offset:27744
    ds_read_b64_tr_b16 v[74:75], v15 offset:28512
    ds_read_b64_tr_b16 v[76:77], v15 offset:27776
    ds_read_b64_tr_b16 v[78:79], v15 offset:28544
    s_waitcnt lgkmcnt(8)
    v_mfma_f32_32x32x16_bf16 v[100:115], v[56:59], v[40:43], v[100:115]
    v_mfma_f32_32x32x16_bf16 v[116:131], v[56:59], v[44:47], v[116:131]
    v_mfma_f32_32x32x16_bf16 v[132:147], v[60:63], v[40:43], v[132:147]
    v_mfma_f32_32x32x16_bf16 v[148:163], v[60:63], v[44:47], v[148:163]
    v_mfma_f32_32x32x16_bf16 v[164:179], v[64:67], v[40:43], v[164:179]
    v_mfma_f32_32x32x16_bf16 v[180:195], v[64:67], v[44:47], v[180:195]
    ds_read_b128 v[40:43], v13 offset:32768
    ds_read_b128 v[44:47], v13 offset:36864
    ds_read_b64_tr_b16 v[56:57], v15 offset:30784
    ds_read_b64_tr_b16 v[58:59], v15 offset:31552
    ds_read_b64_tr_b16 v[60:61], v15 offset:30816
    ds_read_b64_tr_b16 v[62:63], v15 offset:31584
    ds_read_b64_tr_b16 v[64:65], v15 offset:30848
    ds_read_b64_tr_b16 v[66:67], v15 offset:31616
    s_waitcnt lgkmcnt(8)
    v_mfma_f32_32x32x16_bf16 v[100:115], v[68:71], v[48:51], v[100:115]
    v_mfma_f32_32x32x16_bf16 v[116:131], v[68:71], v[52:55], v[116:131]
    v_mfma_f32_32x32x16_bf16 v[132:147], v[72:75], v[48:51], v[132:147]
    v_mfma_f32_32x32x16_bf16 v[148:163], v[72:75], v[52:55], v[148:163]
    v_mfma_f32_32x32x16_bf16 v[164:179], v[76:79], v[48:51], v[164:179]
    v_mfma_f32_32x32x16_bf16 v[180:195], v[76:79], v[52:55], v[180:195]
    ds_read_b128 v[48:51], v14 offset:32768
    ds_read_b128 v[52:55], v14 offset:36864
    ds_read_b64_tr_b16 v[68:69], v15 offset:33856
    ds_read_b64_tr_b16 v[70:71], v15 offset:34624
    ds_read_b64_tr_b16 v[72:73], v15 offset:33888
    ds_read_b64_tr_b16 v[74:75], v15 offset:34656
    ds_read_b64_tr_b16 v[76:77], v15 offset:33920
    ds_read_b64_tr_b16 v[78:79], v15 offset:34688
    s_waitcnt lgkmcnt(8)
    v_mfma_f32_32x32x16_bf16 v[100:115], v[56:59], v[40:43], v[100:115]
    v_mfma_f32_32x32x16_bf16 v[116:131], v[56:59], v[44:47], v[116:131]
    v_mfma_f32_32x32x16_bf16 v[132:147], v[60:63], v[40:43], v[132:147]
    v_mfma_f32_32x32x16_bf16 v[148:163], v[60:63], v[44:47], v[148:163]
    v_mfma_f32_32x32x16_bf16 v[164:179], v[64:67], v[40:43], v[164:179]
    v_mfma_f32_32x32x16_bf16 v[180:195], v[64:67], v[44:47], v[180:195]
    s_waitcnt lgkmcnt(0)
    v_mfma_f32_32x32x16_bf16 v[100:115], v[68:71], v[48:51], v[100:115]
    v_mfma_f32_32x32x16_bf16 v[116:131], v[68:71], v[52:55], v[116:131]
    v_mfma_f32_32x32x16_bf16 v[132:147], v[72:75], v[48:51], v[132:147]
    v_mfma_f32_32x32x16_bf16 v[148:163], v[72:75], v[52:55], v[148:163]
    v_mfma_f32_32x32x16_bf16 v[164:179], v[76:79], v[48:51], v[164:179]
    v_mfma_f32_32x32x16_bf16 v[180:195], v[76:79], v[52:55], v[180:195]
    s_waitcnt vmcnt(0)
    s_barrier
    ds_read_b128 v[40:43], v11 offset:0
    ds_read_b128 v[44:47], v11 offset:4096
    ds_read_b64_tr_b16 v[56:57], v15 offset:0
    ds_read_b64_tr_b16 v[58:59], v15 offset:768
    ds_read_b64_tr_b16 v[60:61], v15 offset:32
    ds_read_b64_tr_b16 v[62:63], v15 offset:800
    ds_read_b64_tr_b16 v[64:65], v15 offset:64
    ds_read_b64_tr_b16 v[66:67], v15 offset:832
    s_add_u32 m0, s44, 32768
    s_nop 0
    buffer_load_dwordx4 v9, s[20:23], s40 offen offset:0 lds
    buffer_load_dwordx4 v10, s[20:23], s41 offen offset:1024 lds
    buffer_load_dwordx4 v9, s[20:23], s42 offen offset:2048 lds
    buffer_load_dwordx4 v10, s[20:23], s43 offen offset:3072 lds
    s_add_u32 m0, s36, 24640
    s_nop 0
    buffer_load_dwordx4 v3, s[24:27], s33 offen offset:0 lds
    buffer_load_dwordx4 v4, s[24:27], s33 offen offset:1024 lds
    buffer_load_dwordx4 v5, s[24:27], s33 offen offset:2048 lds
    s_add_u32 s40, s40, 128
    s_add_u32 s41, s41, 128
    s_add_u32 s42, s42, 128
    s_add_u32 s43, s43, 128
    s_add_u32 s33, s33, s35
    ds_read_b128 v[48:51], v12 offset:0
    ds_read_b128 v[52:55], v12 offset:4096
    ds_read_b64_tr_b16 v[68:69], v15 offset:3072
    ds_read_b64_tr_b16 v[70:71], v15 offset:3840
    ds_read_b64_tr_b16 v[72:73], v15 offset:3104
    ds_read_b64_tr_b16 v[74:75], v15 offset:3872
    ds_read_b64_tr_b16 v[76:77], v15 offset:3136
    ds_read_b64_tr_b16 v[78:79], v15 offset:3904
    s_waitcnt lgkmcnt(8)
    v_mfma_f32_32x32x16_bf16 v[100:115], v[56:59], v[40:43], v[100:115]
    v_mfma_f32_32x32x16_bf16 v[116:131], v[56:59], v[44:47], v[116:131]
    v_mfma_f32_32x32x16_bf16 v[132:147], v[60:63], v[40:43], v[132:147]
    v_mfma_f32_32x32x16_bf16 v[148:163], v[60:63], v[44:47], v[148:163]
    v_mfma_f32_32x32x16_bf16 v[164:179], v[64:67], v[40:43], v[164:179]
    v_mfma_f32_32x32x16_bf16 v[180:195], v[64:67], v[44:47], v[180:195]
    ds_read_b128 v[40:43], v13 offset:0
    ds_read_b128 v[44:47], v13 offset:4096
    ds_read_b64_tr_b16 v[56:57], v15 offset:6144
    ds_read_b64_tr_b16 v[58:59], v15 offset:6912
    ds_read_b64_tr_b16 v[60:61], v15 offset:6176
    ds_read_b64_tr_b16 v[62:63], v15 offset:6944
    ds_read_b64_tr_b16 v[64:65], v15 offset:6208
    ds_read_b64_tr_b16 v[66:67], v15 offset:6976
    s_waitcnt lgkmcnt(8)
    v_mfma_f32_32x32x16_bf16 v[100:115], v[68:71], v[48:51], v[100:115]
    v_mfma_f32_32x32x16_bf16 v[116:131], v[68:71], v[52:55], v[116:131]
    v_mfma_f32_32x32x16_bf16 v[132:147], v[72:75], v[48:51], v[132:147]
    v_mfma_f32_32x32x16_bf16 v[148:163], v[72:75], v[52:55], v[148:163]
    v_mfma_f32_32x32x16_bf16 v[164:179], v[76:79], v[48:51], v[164:179]
    v_mfma_f32_32x32x16_bf16 v[180:195], v[76:79], v[52:55], v[180:195]
    ds_read_b128 v[48:51], v14 offset:0
    ds_read_b128 v[52:55], v14 offset:4096
    ds_read_b64_tr_b16 v[68:69], v15 offset:9216
    ds_read_b64_tr_b16 v[70:71], v15 offset:9984
    ds_read_b64_tr_b16 v[72:73], v15 offset:9248
    ds_read_b64_tr_b16 v[74:75], v15 offset:10016
    ds_read_b64_tr_b16 v[76:77], v15 offset:9280
    ds_read_b64_tr_b16 v[78:79], v15 offset:10048
    s_waitcnt lgkmcnt(8)
    v_mfma_f32_32x32x16_bf16 v[100:115], v[56:59], v[40:43], v[100:115]
    v_mfma_f32_32x32x16_bf16 v[116:131], v[56:59], v[44:47], v[116:131]
    v_mfma_f32_32x32x16_bf16 v[132:147], v[60:63], v[40:43], v[132:147]
    v_mfma_f32_32x32x16_bf16 v[148:163], v[60:63], v[44:47], v[148:163]
    v_mfma_f32_32x32x16_bf16 v[164:179], v[64:67], v[40:43], v[164:179]
    v_mfma_f32_32x32x16_bf16 v[180:195], v[64:67], v[44:47], v[180:195]
    s_waitcnt lgkmcnt(0)
    v_mfma_f32_32x32x16_bf16 v[100:115], v[68:71], v[48:51], v[100:115]
    v_mfma_f32_32x32x16_bf16 v[116:131], v[68:71], v[52:55], v[116:131]
    v_mfma_f32_32x32x16_bf16 v[132:147], v[72:75], v[48:51], v[132:147]
    v_mfma_f32_32x32x16_bf16 v[148:163], v[72:75], v[52:55], v[148:163]
    v_mfma_f32_32x32x16_bf16 v[164:179], v[76:79], v[48:51], v[164:179]
    v_mfma_f32_32x32x16_bf16 v[180:195], v[76:79], v[52:55], v[180:195]
    s_waitcnt vmcnt(0)
    s_barrier
    ds_read_b128 v[40:43], v11 offset:32768
    ds_read_b128 v[44:47], v11 offset:36864
    ds_read_b64_tr_b16 v[56:57], v15 offset:24640
    ds_read_b64_tr_b16 v[58:59], v15 offset:25408
    ds_read_b64_tr_b16 v[60:61], v15 offset:24672
    ds_read_b64_tr_b16 v[62:63], v15 offset:25440
    ds_read_b64_tr_b16 v[64:65], v15 offset:24704
    ds_read_b64_tr_b16 v[66:67], v15 offset:25472
    s_add_u32 m0, s44, 0
    s_nop 0
    buffer_load_dwordx4 v9, s[20:23], s40 offen offset:0 lds
    buffer_load_dwordx4 v10, s[20:23], s41 offen offset:1024 lds
    buffer_load_dwordx4 v9, s[20:23], s42 offen offset:2048 lds
    buffer_load_dwordx4 v10, s[20:23], s43 offen offset:3072 lds
    s_add_u32 m0, s36, 0
    s_nop 0
    buffer_load_dwordx4 v3, s[24:27], s33 offen offset:0 lds
    buffer_load_dwordx4 v4, s[24:27], s33 offen offset:1024 lds
    buffer_load_dwordx4 v5, s[24:27], s33 offen offset:2048 lds
    s_add_u32 s40, s40, 128
    s_add_u32 s41, s41, 128
    s_add_u32 s42, s42, 128
    s_add_u32 s43, s43, 128
    s_add_u32 s33, s33, s35
    ds_read_b128 v[48:51], v12 offset:32768
    ds_read_b128 v[52:55], v12 offset:36864
    ds_read_b64_tr_b16 v[68:69], v15 offset:27712
    ds_read_b64_tr_b16 v[70:71], v15 offset:28480
    ds_read_b64_tr_b16 v[72:73], v15 offset:27744
    ds_read_b64_tr_b16 v[74:75], v15 offset:28512
    ds_read_b64_tr_b16 v[76:77], v15 offset:27776
    ds_read_b64_tr_b16 v[78:79], v15 offset:28544
    s_waitcnt lgkmcnt(8)
    v_mfma_f32_32x32x16_bf16 v[100:115], v[56:59], v[40:43], v[100:115]
    v_mfma_f32_32x32x16_bf16 v[116:131], v[56:59], v[44:47], v[116:131]
    v_mfma_f32_32x32x16_bf16 v[132:147], v[60:63], v[40:43], v[132:147]
    v_mfma_f32_32x32x16_bf16 v[148:163], v[60:63], v[44:47], v[148:163]
    v_mfma_f32_32x32x16_bf16 v[164:179], v[64:67], v[40:43], v[164:179]
    v_mfma_f32_32x32x16_bf16 v[180:195], v[64:67], v[44:47], v[180:195]
    ds_read_b128 v[40:43], v13 offset:32768
    ds_read_b128 v[44:47], v13 offset:36864
    ds_read_b64_tr_b16 v[56:57], v15 offset:30784
    ds_read_b64_tr_b16 v[58:59], v15 offset:31552
    ds_read_b64_tr_b16 v[60:61], v15 offset:30816
    ds_read_b64_tr_b16 v[62:63], v15 offset:31584
    ds_read_b64_tr_b16 v[64:65], v15 offset:30848
    ds_read_b64_tr_b16 v[66:67], v15 offset:31616
    s_waitcnt lgkmcnt(8)
    v_mfma_f32_32x32x16_bf16 v[100:115], v[68:71], v[48:51], v[100:115]
    v_mfma_f32_32x32x16_bf16 v[116:131], v[68:71], v[52:55], v[116:131]
    v_mfma_f32_32x32x16_bf16 v[132:147], v[72:75], v[48:51], v[132:147]
    v_mfma_f32_32x32x16_bf16 v[148:163], v[72:75], v[52:55], v[148:163]
    v_mfma_f32_32x32x16_bf16 v[164:179], v[76:79], v[48:51], v[164:179]
    v_mfma_f32_32x32x16_bf16 v[180:195], v[76:79], v[52:55], v[180:195]
    ds_read_b128 v[48:51], v14 offset:32768
    ds_read_b128 v[52:55], v14 offset:36864
    ds_read_b64_tr_b16 v[68:69], v15 offset:33856
    ds_read_b64_tr_b16 v[70:71], v15 offset:34624
    ds_read_b64_tr_b16 v[72:73], v15 offset:33888
    ds_read_b64_tr_b16 v[74:75], v15 offset:34656
    ds_read_b64_tr_b16 v[76:77], v15 offset:33920
    ds_read_b64_tr_b16 v[78:79], v15 offset:34688
    s_waitcnt lgkmcnt(8)
    v_mfma_f32_32x32x16_bf16 v[100:115], v[56:59], v[40:43], v[100:115]
    v_mfma_f32_32x32x16_bf16 v[116:131], v[56:59], v[44:47], v[116:131]
    v_mfma_f32_32x32x16_bf16 v[132:147], v[60:63], v[40:43], v[132:147]
    v_mfma_f32_32x32x16_bf16 v[148:163], v[60:63], v[44:47], v[148:163]
    v_mfma_f32_32x32x16_bf16 v[164:179], v[64:67], v[40:43], v[164:179]
    v_mfma_f32_32x32x16_bf16 v[180:195], v[64:67], v[44:47], v[180:195]
    s_waitcnt lgkmcnt(0)
    v_mfma_f32_32x32x16_bf16 v[100:115], v[68:71], v[48:51], v[100:115]
    v_mfma_f32_32x32x16_bf16 v[116:131], v[68:71], v[52:55], v[116:131]
    v_mfma_f32_32x32x16_bf16 v[132:147], v[72:75], v[48:51], v[132:147]
    v_mfma_f32_32x32x16_bf16 v[148:163], v[72:75], v[52:55], v[148:163]
    v_mfma_f32_32x32x16_bf16 v[164:179], v[76:79], v[48:51], v[164:179]
    v_mfma_f32_32x32x16_bf16 v[180:195], v[76:79], v[52:55], v[180:195]
    s_waitcnt vmcnt(0)
    s_barrier
    ds_read_b128 v[40:43], v11 offset:0
    ds_read_b128 v[44:47], v11 offset:4096
    ds_read_b64_tr_b16 v[56:57], v15 offset:0
    ds_read_b64_tr_b16 v[58:59], v15 offset:768
    ds_read_b64_tr_b16 v[60:61], v15 offset:32
    ds_read_b64_tr_b16 v[62:63], v15 offset:800
    ds_read_b64_tr_b16 v[64:65], v15 offset:64
    ds_read_b64_tr_b16 v[66:67], v15 offset:832
    s_add_u32 m0, s44, 32768
    s_nop 0
    buffer_load_dwordx4 v9, s[20:23], s40 offen offset:0 lds
    buffer_load_dwordx4 v10, s[20:23], s41 offen offset:1024 lds
    buffer_load_dwordx4 v9, s[20:23], s42 offen offset:2048 lds
    buffer_load_dwordx4 v10, s[20:23], s43 offen offset:3072 lds
    s_add_u32 m0, s36, 24640
    s_nop 0
    buffer_load_dwordx4 v3, s[24:27], s33 offen offset:0 lds
    buffer_load_dwordx4 v4, s[24:27], s33 offen offset:1024 lds
    buffer_load_dwordx4 v5, s[24:27], s33 offen offset:2048 lds
    s_add_u32 s40, s40, 128
    s_add_u32 s41, s41, 128
    s_add_u32 s42, s42, 128
    s_add_u32 s43, s43, 128
    s_add_u32 s33, s33, s35
    ds_read_b128 v[48:51], v12 offset:0
    ds_read_b128 v[52:55], v12 offset:4096
    ds_read_b64_tr_b16 v[68:69], v15 offset:3072
    ds_read_b64_tr_b16 v[70:71], v15 offset:3840
    ds_read_b64_tr_b16 v[72:73], v15 offset:3104
    ds_read_b64_tr_b16 v[74:75], v15 offset:3872
    ds_read_b64_tr_b16 v[76:77], v15 offset:3136
    ds_read_b64_tr_b16 v[78:79], v15 offset:3904
    s_waitcnt lgkmcnt(8)
    v_mfma_f32_32x32x16_bf16 v[100:115], v[56:59], v[40:43], v[100:115]
    v_mfma_f32_32x32x16_bf16 v[116:131], v[56:59], v[44:47], v[116:131]
    v_mfma_f32_32x32x16_bf16 v[132:147], v[60:63], v[40:43], v[132:147]
    v_mfma_f32_32x32x16_bf16 v[148:163], v[60:63], v[44:47], v[148:163]
    v_mfma_f32_32x32x16_bf16 v[164:179], v[64:67], v[40:43], v[164:179]
    v_mfma_f32_32x32x16_bf16 v[180:195], v[64:67], v[44:47], v[180:195]
    ds_read_b128 v[40:43], v13 offset:0
    ds_read_b128 v[44:47], v13 offset:4096
    ds_read_b64_tr_b16 v[56:57], v15 offset:6144
    ds_read_b64_tr_b16 v[58:59], v15 offset:6912
    ds_read_b64_tr_b16 v[60:61], v15 offset:6176
    ds_read_b64_tr_b16 v[62:63], v15 offset:6944
    ds_read_b64_tr_b16 v[64:65], v15 offset:6208
    ds_read_b64_tr_b16 v[66:67], v15 offset:6976
    s_waitcnt lgkmcnt(8)
    v_mfma_f32_32x32x16_bf16 v[100:115], v[68:71], v[48:51], v[100:115]
    v_mfma_f32_32x32x16_bf16 v[116:131], v[68:71], v[52:55], v[116:131]
    v_mfma_f32_32x32x16_bf16 v[132:147], v[72:75], v[48:51], v[132:147]
    v_mfma_f32_32x32x16_bf16 v[148:163], v[72:75], v[52:55], v[148:163]
    v_mfma_f32_32x32x16_bf16 v[164:179], v[76:79], v[48:51], v[164:179]
    v_mfma_f32_32x32x16_bf16 v[180:195], v[76:79], v[52:55], v[180:195]
    ds_read_b128 v[48:51], v14 offset:0
    ds_read_b128 v[52:55], v14 offset:4096
    ds_read_b64_tr_b16 v[68:69], v15 offset:9216
    ds_read_b64_tr_b16 v[70:71], v15 offset:9984
    ds_read_b64_tr_b16 v[72:73], v15 offset:9248
    ds_read_b64_tr_b16 v[74:75], v15 offset:10016
    ds_read_b64_tr_b16 v[76:77], v15 offset:9280
    ds_read_b64_tr_b16 v[78:79], v15 offset:10048
    s_waitcnt lgkmcnt(8)
    v_mfma_f32_32x32x16_bf16 v[100:115], v[56:59], v[40:43], v[100:115]
    v_mfma_f32_32x32x16_bf16 v[116:131], v[56:59], v[44:47], v[116:131]
    v_mfma_f32_32x32x16_bf16 v[132:147], v[60:63], v[40:43], v[132:147]
    v_mfma_f32_32x32x16_bf16 v[148:163], v[60:63], v[44:47], v[148:163]
    v_mfma_f32_32x32x16_bf16 v[164:179], v[64:67], v[40:43], v[164:179]
    v_mfma_f32_32x32x16_bf16 v[180:195], v[64:67], v[44:47], v[180:195]
    s_waitcnt lgkmcnt(0)
    v_mfma_f32_32x32x16_bf16 v[100:115], v[68:71], v[48:51], v[100:115]
    v_mfma_f32_32x32x16_bf16 v[116:131], v[68:71], v[52:55], v[116:131]
    v_mfma_f32_32x32x16_bf16 v[132:147], v[72:75], v[48:51], v[132:147]
    v_mfma_f32_32x32x16_bf16 v[148:163], v[72:75], v[52:55], v[148:163]
    v_mfma_f32_32x32x16_bf16 v[164:179], v[76:79], v[48:51], v[164:179]
    v_mfma_f32_32x32x16_bf16 v[180:195], v[76:79], v[52:55], v[180:195]
    s_waitcnt vmcnt(0)
    s_barrier
    ds_read_b128 v[40:43], v11 offset:32768
    ds_read_b128 v[44:47], v11 offset:36864
    ds_read_b64_tr_b16 v[56:57], v15 offset:24640
    ds_read_b64_tr_b16 v[58:59], v15 offset:25408
    ds_read_b64_tr_b16 v[60:61], v15 offset:24672
    ds_read_b64_tr_b16 v[62:63], v15 offset:25440
    ds_read_b64_tr_b16 v[64:65], v15 offset:24704
    ds_read_b64_tr_b16 v[66:67], v15 offset:25472
    ds_read_b128 v[48:51], v12 offset:32768
    ds_read_b128 v[52:55], v12 offset:36864
    ds_read_b64_tr_b16 v[68:69], v15 offset:27712
    ds_read_b64_tr_b16 v[70:71], v15 offset:28480
    ds_read_b64_tr_b16 v[72:73], v15 offset:27744
    ds_read_b64_tr_b16 v[74:75], v15 offset:28512
    ds_read_b64_tr_b16 v[76:77], v15 offset:27776
    ds_read_b64_tr_b16 v[78:79], v15 offset:28544
    s_waitcnt lgkmcnt(8)
    v_mfma_f32_32x32x16_bf16 v[100:115], v[56:59], v[40:43], v[100:115]
    v_mfma_f32_32x32x16_bf16 v[116:131], v[56:59], v[44:47], v[116:131]
    v_mfma_f32_32x32x16_bf16 v[132:147], v[60:63], v[40:43], v[132:147]
    v_mfma_f32_32x32x16_bf16 v[148:163], v[60:63], v[44:47], v[148:163]
    v_mfma_f32_32x32x16_bf16 v[164:179], v[64:67], v[40:43], v[164:179]
    v_mfma_f32_32x32x16_bf16 v[180:195], v[64:67], v[44:47], v[180:195]
    ds_read_b128 v[40:43], v13 offset:32768
    ds_read_b128 v[44:47], v13 offset:36864
    ds_read_b64_tr_b16 v[56:57], v15 offset:30784
    ds_read_b64_tr_b16 v[58:59], v15 offset:31552
    ds_read_b64_tr_b16 v[60:61], v15 offset:30816
    ds_read_b64_tr_b16 v[62:63], v15 offset:31584
    ds_read_b64_tr_b16 v[64:65], v15 offset:30848
    ds_read_b64_tr_b16 v[66:67], v15 offset:31616
    s_waitcnt lgkmcnt(8)
    v_mfma_f32_32x32x16_bf16 v[100:115], v[68:71], v[48:51], v[100:115]
    v_mfma_f32_32x32x16_bf16 v[116:131], v[68:71], v[52:55], v[116:131]
    v_mfma_f32_32x32x16_bf16 v[132:147], v[72:75], v[48:51], v[132:147]
    v_mfma_f32_32x32x16_bf16 v[148:163], v[72:75], v[52:55], v[148:163]
    v_mfma_f32_32x32x16_bf16 v[164:179], v[76:79], v[48:51], v[164:179]
    v_mfma_f32_32x32x16_bf16 v[180:195], v[76:79], v[52:55], v[180:195]
    ds_read_b128 v[48:51], v14 offset:32768
    ds_read_b128 v[52:55], v14 offset:36864
    ds_read_b64_tr_b16 v[68:69], v15 offset:33856
    ds_read_b64_tr_b16 v[70:71], v15 offset:34624
    ds_read_b64_tr_b16 v[72:73], v15 offset:33888
    ds_read_b64_tr_b16 v[74:75], v15 offset:34656
    ds_read_b64_tr_b16 v[76:77], v15 offset:33920
    ds_read_b64_tr_b16 v[78:79], v15 offset:34688
    s_waitcnt lgkmcnt(8)
    v_mfma_f32_32x32x16_bf16 v[100:115], v[56:59], v[40:43], v[100:115]
    v_mfma_f32_32x32x16_bf16 v[116:131], v[56:59], v[44:47], v[116:131]
    v_mfma_f32_32x32x16_bf16 v[132:147], v[60:63], v[40:43], v[132:147]
    v_mfma_f32_32x32x16_bf16 v[148:163], v[60:63], v[44:47], v[148:163]
    v_mfma_f32_32x32x16_bf16 v[164:179], v[64:67], v[40:43], v[164:179]
    v_mfma_f32_32x32x16_bf16 v[180:195], v[64:67], v[44:47], v[180:195]
    s_waitcnt lgkmcnt(0)
    v_mfma_f32_32x32x16_bf16 v[100:115], v[68:71], v[48:51], v[100:115]
    v_mfma_f32_32x32x16_bf16 v[116:131], v[68:71], v[52:55], v[116:131]
    v_mfma_f32_32x32x16_bf16 v[132:147], v[72:75], v[48:51], v[132:147]
    v_mfma_f32_32x32x16_bf16 v[148:163], v[72:75], v[52:55], v[148:163]
    v_mfma_f32_32x32x16_bf16 v[164:179], v[76:79], v[48:51], v[164:179]
    v_mfma_f32_32x32x16_bf16 v[180:195], v[76:79], v[52:55], v[180:195]
    s_nop 15
    s_nop 15
    s_barrier
    v_and_b32 v6, 31, v2
    v_add_u32 v6, s45, v6
    v_mul_u32_u24 v6, 400, v6
    v_lshrrev_b32 v7, 5, v2
    v_lshl_add_u32 v6, v7, 3, v6
    s_and_b32 s53, s17, 1
    s_mul_i32 s53, s53, 96
    v_add_u32 v6, s53, v6
    s_cmp_ge_u32 s15, 10
    s_cbranch_scc1 g1_epi_glu
    v_cvt_pk_bf16_f32 v20, v100, v101
    v_cvt_pk_bf16_f32 v21, v102, v103
    v_cvt_pk_bf16_f32 v22, v104, v105
    v_cvt_pk_bf16_f32 v23, v106, v107
    v_cvt_pk_bf16_f32 v24, v108, v109
    v_cvt_pk_bf16_f32 v25, v110, v111
    v_cvt_pk_bf16_f32 v26, v112, v113
    v_cvt_pk_bf16_f32 v27, v114, v115
    ds_write_b64 v6, v[20:21] offset:0
    ds_write_b64 v6, v[22:23] offset:16
    ds_write_b64 v6, v[24:25] offset:192
    ds_write_b64 v6, v[26:27] offset:208
    v_cvt_pk_bf16_f32 v20, v116, v117
    v_cvt_pk_bf16_f32 v21, v118, v119
    v_cvt_pk_bf16_f32 v22, v120, v121
    v_cvt_pk_bf16_f32 v23, v122, v123
    v_cvt_pk_bf16_f32 v24, v124, v125
    v_cvt_pk_bf16_f32 v25, v126, v127
    v_cvt_pk_bf16_f32 v26, v128, v129
    v_cvt_pk_bf16_f32 v27, v130, v131
    ds_write_b64 v6, v[20:21] offset:12800
    ds_write_b64 v6, v[22:23] offset:12816
    ds_write_b64 v6, v[24:25] offset:12992
    ds_write_b64 v6, v[26:27] offset:13008
    v_cvt_pk_bf16_f32 v20, v132, v133
    v_cvt_pk_bf16_f32 v21, v134, v135
    v_cvt_pk_bf16_f32 v22, v136, v137
    v_cvt_pk_bf16_f32 v23, v138, v139
    v_cvt_pk_bf16_f32 v24, v140, v141
    v_cvt_pk_bf16_f32 v25, v142, v143
    v_cvt_pk_bf16_f32 v26, v144, v145
    v_cvt_pk_bf16_f32 v27, v146, v147
    ds_write_b64 v6, v[20:21] offset:32
    ds_write_b64 v6, v[22:23] offset:48
    ds_write_b64 v6, v[24:25] offset:224
    ds_write_b64 v6, v[26:27] offset:240
    v_cvt_pk_bf16_f32 v20, v148, v149
    v_cvt_pk_bf16_f32 v21, v150, v151
    v_cvt_pk_bf16_f32 v22, v152, v153
    v_cvt_pk_bf16_f32 v23, v154, v155
    v_cvt_pk_bf16_f32 v24, v156, v157
    v_cvt_pk_bf16_f32 v25, v158, v159
    v_cvt_pk_bf16_f32 v26, v160, v161
    v_cvt_pk_bf16_f32 v27, v162, v163
    ds_write_b64 v6, v[20:21] offset:12832
    ds_write_b64 v6, v[22:23] offset:12848
    ds_write_b64 v6, v[24:25] offset:13024
    ds_write_b64 v6, v[26:27] offset:13040
    v_cvt_pk_bf16_f32 v20, v164, v165
    v_cvt_pk_bf16_f32 v21, v166, v167
    v_cvt_pk_bf16_f32 v22, v168, v169
    v_cvt_pk_bf16_f32 v23, v170, v171
    v_cvt_pk_bf16_f32 v24, v172, v173
    v_cvt_pk_bf16_f32 v25, v174, v175
    v_cvt_pk_bf16_f32 v26, v176, v177
    v_cvt_pk_bf16_f32 v27, v178, v179
    ds_write_b64 v6, v[20:21] offset:64
    ds_write_b64 v6, v[22:23] offset:80
    ds_write_b64 v6, v[24:25] offset:256
    ds_write_b64 v6, v[26:27] offset:272
    v_cvt_pk_bf16_f32 v20, v180, v181
    v_cvt_pk_bf16_f32 v21, v182, v183
    v_cvt_pk_bf16_f32 v22, v184, v185
    v_cvt_pk_bf16_f32 v23, v186, v187
    v_cvt_pk_bf16_f32 v24, v188, v189
    v_cvt_pk_bf16_f32 v25, v190, v191
    v_cvt_pk_bf16_f32 v26, v192, v193
    v_cvt_pk_bf16_f32 v27, v194, v195
    ds_write_b64 v6, v[20:21] offset:12864
    ds_write_b64 v6, v[22:23] offset:12880
    ds_write_b64 v6, v[24:25] offset:13056
    ds_write_b64 v6, v[26:27] offset:13072
    s_waitcnt lgkmcnt(0)
    s_barrier
    s_add_u32 s6, s6, 4194304
    s_addc_u32 s7, s7, 0
    s_mov_b32 s48, s6
    s_and_b32 s49, s7, 0xffff
    s_mov_b32 s50, 7864320
    s_mov_b32 s51, 0x20000
    v_add_u32 v8, 0, v2
    v_mul_u32_u24 v9, 0xaaab, v8
    v_lshrrev_b32 v9, 20, v9
    v_mul_u32_u24 v10, 24, v9
    v_sub_u32 v10, v8, v10
    s_lshl_b32 s54, s17, 5
    v_add_u32 v9, s54, v9
    v_mul_u32_u24 v11, 400, v9
    v_lshl_add_u32 v11, v10, 4, v11
    ds_read_b128 v[20:23], v11
    s_lshl_b32 s54, s14, 8
    v_add_u32 v9, s54, v9
    v_mul_u32_u24 v9, 0xf00, v9
    v_lshl_add_u32 v9, v10, 4, v9
    s_mul_i32 s52, s15, 384
    s_waitcnt lgkmcnt(0)
    buffer_store_dwordx4 v[20:23], v9, s[48:51], s52 offen
    v_add_u32 v8, 64, v2
    v_mul_u32_u24 v9, 0xaaab, v8
    v_lshrrev_b32 v9, 20, v9
    v_mul_u32_u24 v10, 24, v9
    v_sub_u32 v10, v8, v10
    s_lshl_b32 s54, s17, 5
    v_add_u32 v9, s54, v9
    v_mul_u32_u24 v11, 400, v9
    v_lshl_add_u32 v11, v10, 4, v11
    ds_read_b128 v[20:23], v11
    s_lshl_b32 s54, s14, 8
    v_add_u32 v9, s54, v9
    v_mul_u32_u24 v9, 0xf00, v9
    v_lshl_add_u32 v9, v10, 4, v9
    s_mul_i32 s52, s15, 384
    s_waitcnt lgkmcnt(0)
    buffer_store_dwordx4 v[20:23], v9, s[48:51], s52 offen
    v_add_u32 v8, 128, v2
    v_mul_u32_u24 v9, 0xaaab, v8
    v_lshrrev_b32 v9, 20, v9
    v_mul_u32_u24 v10, 24, v9
    v_sub_u32 v10, v8, v10
    s_lshl_b32 s54, s17, 5
    v_add_u32 v9, s54, v9
    v_mul_u32_u24 v11, 400, v9
    v_lshl_add_u32 v11, v10, 4, v11
    ds_read_b128 v[20:23], v11
    s_lshl_b32 s54, s14, 8
    v_add_u32 v9, s54, v9
    v_mul_u32_u24 v9, 0xf00, v9
    v_lshl_add_u32 v9, v10, 4, v9
    s_mul_i32 s52, s15, 384
    s_waitcnt lgkmcnt(0)
    buffer_store_dwordx4 v[20:23], v9, s[48:51], s52 offen
    v_add_u32 v8, 192, v2
    v_mul_u32_u24 v9, 0xaaab, v8
    v_lshrrev_b32 v9, 20, v9
    v_mul_u32_u24 v10, 24, v9
    v_sub_u32 v10, v8, v10
    s_lshl_b32 s54, s17, 5
    v_add_u32 v9, s54, v9
    v_mul_u32_u24 v11, 400, v9
    v_lshl_add_u32 v11, v10, 4, v11
    ds_read_b128 v[20:23], v11
    s_lshl_b32 s54, s14, 8
    v_add_u32 v9, s54, v9
    v_mul_u32_u24 v9, 0xf00, v9
    v_lshl_add_u32 v9, v10, 4, v9
    s_mul_i32 s52, s15, 384
    s_waitcnt lgkmcnt(0)
    buffer_store_dwordx4 v[20:23], v9, s[48:51], s52 offen
    v_add_u32 v8, 256, v2
    v_mul_u32_u24 v9, 0xaaab, v8
    v_lshrrev_b32 v9, 20, v9
    v_mul_u32_u24 v10, 24, v9
    v_sub_u32 v10, v8, v10
    s_lshl_b32 s54, s17, 5
    v_add_u32 v9, s54, v9
    v_mul_u32_u24 v11, 400, v9
    v_lshl_add_u32 v11, v10, 4, v11
    ds_read_b128 v[20:23], v11
    s_lshl_b32 s54, s14, 8
    v_add_u32 v9, s54, v9
    v_mul_u32_u24 v9, 0xf00, v9
    v_lshl_add_u32 v9, v10, 4, v9
    s_mul_i32 s52, s15, 384
    s_waitcnt lgkmcnt(0)
    buffer_store_dwordx4 v[20:23], v9, s[48:51], s52 offen
    v_add_u32 v8, 320, v2
    v_mul_u32_u24 v9, 0xaaab, v8
    v_lshrrev_b32 v9, 20, v9
    v_mul_u32_u24 v10, 24, v9
    v_sub_u32 v10, v8, v10
    s_lshl_b32 s54, s17, 5
    v_add_u32 v9, s54, v9
    v_mul_u32_u24 v11, 400, v9
    v_lshl_add_u32 v11, v10, 4, v11
    ds_read_b128 v[20:23], v11
    s_lshl_b32 s54, s14, 8
    v_add_u32 v9, s54, v9
    v_mul_u32_u24 v9, 0xf00, v9
    v_lshl_add_u32 v9, v10, 4, v9
    s_mul_i32 s52, s15, 384
    s_waitcnt lgkmcnt(0)
    buffer_store_dwordx4 v[20:23], v9, s[48:51], s52 offen
    v_add_u32 v8, 384, v2
    v_mul_u32_u24 v9, 0xaaab, v8
    v_lshrrev_b32 v9, 20, v9
    v_mul_u32_u24 v10, 24, v9
    v_sub_u32 v10, v8, v10
    s_lshl_b32 s54, s17, 5
    v_add_u32 v9, s54, v9
    v_mul_u32_u24 v11, 400, v9
    v_lshl_add_u32 v11, v10, 4, v11
    ds_read_b128 v[20:23], v11
    s_lshl_b32 s54, s14, 8
    v_add_u32 v9, s54, v9
    v_mul_u32_u24 v9, 0xf00, v9
    v_lshl_add_u32 v9, v10, 4, v9
    s_mul_i32 s52, s15, 384
    s_waitcnt lgkmcnt(0)
    buffer_store_dwordx4 v[20:23], v9, s[48:51], s52 offen
    v_add_u32 v8, 448, v2
    v_mul_u32_u24 v9, 0xaaab, v8
    v_lshrrev_b32 v9, 20, v9
    v_mul_u32_u24 v10, 24, v9
    v_sub_u32 v10, v8, v10
    s_lshl_b32 s54, s17, 5
    v_add_u32 v9, s54, v9
    v_mul_u32_u24 v11, 400, v9
    v_lshl_add_u32 v11, v10, 4, v11
    ds_read_b128 v[20:23], v11
    s_lshl_b32 s54, s14, 8
    v_add_u32 v9, s54, v9
    v_mul_u32_u24 v9, 0xf00, v9
    v_lshl_add_u32 v9, v10, 4, v9
    s_mul_i32 s52, s15, 384
    s_waitcnt lgkmcnt(0)
    buffer_store_dwordx4 v[20:23], v9, s[48:51], s52 offen
    v_add_u32 v8, 512, v2
    v_mul_u32_u24 v9, 0xaaab, v8
    v_lshrrev_b32 v9, 20, v9
    v_mul_u32_u24 v10, 24, v9
    v_sub_u32 v10, v8, v10
    s_lshl_b32 s54, s17, 5
    v_add_u32 v9, s54, v9
    v_mul_u32_u24 v11, 400, v9
    v_lshl_add_u32 v11, v10, 4, v11
    ds_read_b128 v[20:23], v11
    s_lshl_b32 s54, s14, 8
    v_add_u32 v9, s54, v9
    v_mul_u32_u24 v9, 0xf00, v9
    v_lshl_add_u32 v9, v10, 4, v9
    s_mul_i32 s52, s15, 384
    s_waitcnt lgkmcnt(0)
    buffer_store_dwordx4 v[20:23], v9, s[48:51], s52 offen
    v_add_u32 v8, 576, v2
    v_mul_u32_u24 v9, 0xaaab, v8
    v_lshrrev_b32 v9, 20, v9
    v_mul_u32_u24 v10, 24, v9
    v_sub_u32 v10, v8, v10
    s_lshl_b32 s54, s17, 5
    v_add_u32 v9, s54, v9
    v_mul_u32_u24 v11, 400, v9
    v_lshl_add_u32 v11, v10, 4, v11
    ds_read_b128 v[20:23], v11
    s_lshl_b32 s54, s14, 8
    v_add_u32 v9, s54, v9
    v_mul_u32_u24 v9, 0xf00, v9
    v_lshl_add_u32 v9, v10, 4, v9
    s_mul_i32 s52, s15, 384
    s_waitcnt lgkmcnt(0)
    buffer_store_dwordx4 v[20:23], v9, s[48:51], s52 offen
    v_add_u32 v8, 640, v2
    v_mul_u32_u24 v9, 0xaaab, v8
    v_lshrrev_b32 v9, 20, v9
    v_mul_u32_u24 v10, 24, v9
    v_sub_u32 v10, v8, v10
    s_lshl_b32 s54, s17, 5
    v_add_u32 v9, s54, v9
    v_mul_u32_u24 v11, 400, v9
    v_lshl_add_u32 v11, v10, 4, v11
    ds_read_b128 v[20:23], v11
    s_lshl_b32 s54, s14, 8
    v_add_u32 v9, s54, v9
    v_mul_u32_u24 v9, 0xf00, v9
    v_lshl_add_u32 v9, v10, 4, v9
    s_mul_i32 s52, s15, 384
    s_waitcnt lgkmcnt(0)
    buffer_store_dwordx4 v[20:23], v9, s[48:51], s52 offen
    v_add_u32 v8, 704, v2
    v_mul_u32_u24 v9, 0xaaab, v8
    v_lshrrev_b32 v9, 20, v9
    v_mul_u32_u24 v10, 24, v9
    v_sub_u32 v10, v8, v10
    s_lshl_b32 s54, s17, 5
    v_add_u32 v9, s54, v9
    v_mul_u32_u24 v11, 400, v9
    v_lshl_add_u32 v11, v10, 4, v11
    ds_read_b128 v[20:23], v11
    s_lshl_b32 s54, s14, 8
    v_add_u32 v9, s54, v9
    v_mul_u32_u24 v9, 0xf00, v9
    v_lshl_add_u32 v9, v10, 4, v9
    s_mul_i32 s52, s15, 384
    s_waitcnt lgkmcnt(0)
    buffer_store_dwordx4 v[20:23], v9, s[48:51], s52 offen
    s_branch g1_end
g1_epi_glu:
    v_cvt_pk_bf16_f32 v20, v100, v101
    v_cvt_pk_bf16_f32 v21, v102, v103
    v_cvt_pk_bf16_f32 v22, v104, v105
    v_cvt_pk_bf16_f32 v23, v106, v107
    v_cvt_pk_bf16_f32 v24, v108, v109
    v_cvt_pk_bf16_f32 v25, v110, v111
    v_cvt_pk_bf16_f32 v26, v112, v113
    v_cvt_pk_bf16_f32 v27, v114, v115
    s_nop 0
    v_lshlrev_b32 v28, 16, v20
    v_and_b32 v29, 0xffff0000, v20
    v_lshlrev_b32 v36, 16, v24
    v_and_b32 v37, 0xffff0000, v24
    v_max_f32 v28, 0, v28
    v_max_f32 v29, 0, v29
    v_mul_f32 v28, v28, v36
    v_mul_f32 v29, v29, v37
    v_lshlrev_b32 v30, 16, v21
    v_and_b32 v31, 0xffff0000, v21
    v_lshlrev_b32 v36, 16, v25
    v_and_b32 v37, 0xffff0000, v25
    v_max_f32 v30, 0, v30
    v_max_f32 v31, 0, v31
    v_mul_f32 v30, v30, v36
    v_mul_f32 v31, v31, v37
    v_lshlrev_b32 v32, 16, v22
    v_and_b32 v33, 0xffff0000, v22
    v_lshlrev_b32 v36, 16, v26
    v_and_b32 v37, 0xffff0000, v26
    v_max_f32 v32, 0, v32
    v_max_f32 v33, 0, v33
    v_mul_f32 v32, v32, v36
    v_mul_f32 v33, v33, v37
    v_lshlrev_b32 v34, 16, v23
    v_and_b32 v35, 0xffff0000, v23
    v_lshlrev_b32 v36, 16, v27
    v_and_b32 v37, 0xffff0000, v27
    v_max_f32 v34, 0, v34
    v_max_f32 v35, 0, v35
    v_mul_f32 v34, v34, v36
    v_mul_f32 v35, v35, v37
    v_cvt_pk_bf16_f32 v20, v28, v29
    v_cvt_pk_bf16_f32 v21, v30, v31
    v_cvt_pk_bf16_f32 v22, v32, v33
    v_cvt_pk_bf16_f32 v23, v34, v35
    ds_write_b64 v6, v[20:21] offset:0
    ds_write_b64 v6, v[22:23] offset:16
    v_cvt_pk_bf16_f32 v20, v116, v117
    v_cvt_pk_bf16_f32 v21, v118, v119
    v_cvt_pk_bf16_f32 v22, v120, v121
    v_cvt_pk_bf16_f32 v23, v122, v123
    v_cvt_pk_bf16_f32 v24, v124, v125
    v_cvt_pk_bf16_f32 v25, v126, v127
    v_cvt_pk_bf16_f32 v26, v128, v129
    v_cvt_pk_bf16_f32 v27, v130, v131
    s_nop 0
    v_lshlrev_b32 v28, 16, v20
    v_and_b32 v29, 0xffff0000, v20
    v_lshlrev_b32 v36, 16, v24
    v_and_b32 v37, 0xffff0000, v24
    v_max_f32 v28, 0, v28
    v_max_f32 v29, 0, v29
    v_mul_f32 v28, v28, v36
    v_mul_f32 v29, v29, v37
    v_lshlrev_b32 v30, 16, v21
    v_and_b32 v31, 0xffff0000, v21
    v_lshlrev_b32 v36, 16, v25
    v_and_b32 v37, 0xffff0000, v25
    v_max_f32 v30, 0, v30
    v_max_f32 v31, 0, v31
    v_mul_f32 v30, v30, v36
    v_mul_f32 v31, v31, v37
    v_lshlrev_b32 v32, 16, v22
    v_and_b32 v33, 0xffff0000, v22
    v_lshlrev_b32 v36, 16, v26
    v_and_b32 v37, 0xffff0000, v26
    v_max_f32 v32, 0, v32
    v_max_f32 v33, 0, v33
    v_mul_f32 v32, v32, v36
    v_mul_f32 v33, v33, v37
    v_lshlrev_b32 v34, 16, v23
    v_and_b32 v35, 0xffff0000, v23
    v_lshlrev_b32 v36, 16, v27
    v_and_b32 v37, 0xffff0000, v27
    v_max_f32 v34, 0, v34
    v_max_f32 v35, 0, v35
    v_mul_f32 v34, v34, v36
    v_mul_f32 v35, v35, v37
    v_cvt_pk_bf16_f32 v20, v28, v29
    v_cvt_pk_bf16_f32 v21, v30, v31
    v_cvt_pk_bf16_f32 v22, v32, v33
    v_cvt_pk_bf16_f32 v23, v34, v35
    ds_write_b64 v6, v[20:21] offset:12800
    ds_write_b64 v6, v[22:23] offset:12816
    v_cvt_pk_bf16_f32 v20, v132, v133
    v_cvt_pk_bf16_f32 v21, v134, v135
    v_cvt_pk_bf16_f32 v22, v136, v137
    v_cvt_pk_bf16_f32 v23, v138, v139
    v_cvt_pk_bf16_f32 v24, v140, v141
    v_cvt_pk_bf16_f32 v25, v142, v143
    v_cvt_pk_bf16_f32 v26, v144, v145
    v_cvt_pk_bf16_f32 v27, v146, v147
    s_nop 0
    v_lshlrev_b32 v28, 16, v20
    v_and_b32 v29, 0xffff0000, v20
    v_lshlrev_b32 v36, 16, v24
    v_and_b32 v37, 0xffff0000, v24
    v_max_f32 v28, 0, v28
    v_max_f32 v29, 0, v29
    v_mul_f32 v28, v28, v36
    v_mul_f32 v29, v29, v37
    v_lshlrev_b32 v30, 16, v21
    v_and_b32 v31, 0xffff0000, v21
    v_lshlrev_b32 v36, 16, v25
    v_and_b32 v37, 0xffff0000, v25
    v_max_f32 v30, 0, v30
    v_max_f32 v31, 0, v31
    v_mul_f32 v30, v30, v36
    v_mul_f32 v31, v31, v37
    v_lshlrev_b32 v32, 16, v22
    v_and_b32 v33, 0xffff0000, v22
    v_lshlrev_b32 v36, 16, v26
    v_and_b32 v37, 0xffff0000, v26
    v_max_f32 v32, 0, v32
    v_max_f32 v33, 0, v33
    v_mul_f32 v32, v32, v36
    v_mul_f32 v33, v33, v37
    v_lshlrev_b32 v34, 16, v23
    v_and_b32 v35, 0xffff0000, v23
    v_lshlrev_b32 v36, 16, v27
    v_and_b32 v37, 0xffff0000, v27
    v_max_f32 v34, 0, v34
    v_max_f32 v35, 0, v35
    v_mul_f32 v34, v34, v36
    v_mul_f32 v35, v35, v37
    v_cvt_pk_bf16_f32 v20, v28, v29
    v_cvt_pk_bf16_f32 v21, v30, v31
    v_cvt_pk_bf16_f32 v22, v32, v33
    v_cvt_pk_bf16_f32 v23, v34, v35
    ds_write_b64 v6, v[20:21] offset:32
    ds_write_b64 v6, v[22:23] offset:48
    v_cvt_pk_bf16_f32 v20, v148, v149
    v_cvt_pk_bf16_f32 v21, v150, v151
    v_cvt_pk_bf16_f32 v22, v152, v153
    v_cvt_pk_bf16_f32 v23, v154, v155
    v_cvt_pk_bf16_f32 v24, v156, v157
    v_cvt_pk_bf16_f32 v25, v158, v159
    v_cvt_pk_bf16_f32 v26, v160, v161
    v_cvt_pk_bf16_f32 v27, v162, v163
    s_nop 0
    v_lshlrev_b32 v28, 16, v20
    v_and_b32 v29, 0xffff0000, v20
    v_lshlrev_b32 v36, 16, v24
    v_and_b32 v37, 0xffff0000, v24
    v_max_f32 v28, 0, v28
    v_max_f32 v29, 0, v29
    v_mul_f32 v28, v28, v36
    v_mul_f32 v29, v29, v37
    v_lshlrev_b32 v30, 16, v21
    v_and_b32 v31, 0xffff0000, v21
    v_lshlrev_b32 v36, 16, v25
    v_and_b32 v37, 0xffff0000, v25
    v_max_f32 v30, 0, v30
    v_max_f32 v31, 0, v31
    v_mul_f32 v30, v30, v36
    v_mul_f32 v31, v31, v37
    v_lshlrev_b32 v32, 16, v22
    v_and_b32 v33, 0xffff0000, v22
    v_lshlrev_b32 v36, 16, v26
    v_and_b32 v37, 0xffff0000, v26
    v_max_f32 v32, 0, v32
    v_max_f32 v33, 0, v33
    v_mul_f32 v32, v32, v36
    v_mul_f32 v33, v33, v37
    v_lshlrev_b32 v34, 16, v23
    v_and_b32 v35, 0xffff0000, v23
    v_lshlrev_b32 v36, 16, v27
    v_and_b32 v37, 0xffff0000, v27
    v_max_f32 v34, 0, v34
    v_max_f32 v35, 0, v35
    v_mul_f32 v34, v34, v36
    v_mul_f32 v35, v35, v37
    v_cvt_pk_bf16_f32 v20, v28, v29
    v_cvt_pk_bf16_f32 v21, v30, v31
    v_cvt_pk_bf16_f32 v22, v32, v33
    v_cvt_pk_bf16_f32 v23, v34, v35
    ds_write_b64 v6, v[20:21] offset:12832
    ds_write_b64 v6, v[22:23] offset:12848
    v_cvt_pk_bf16_f32 v20, v164, v165
    v_cvt_pk_bf16_f32 v21, v166, v167
    v_cvt_pk_bf16_f32 v22, v168, v169
    v_cvt_pk_bf16_f32 v23, v170, v171
    v_cvt_pk_bf16_f32 v24, v172, v173
    v_cvt_pk_bf16_f32 v25, v174, v175
    v_cvt_pk_bf16_f32 v26, v176, v177
    v_cvt_pk_bf16_f32 v27, v178, v179
    s_nop 0
    v_lshlrev_b32 v28, 16, v20
    v_and_b32 v29, 0xffff0000, v20
    v_lshlrev_b32 v36, 16, v24
    v_and_b32 v37, 0xffff0000, v24
    v_max_f32 v28, 0, v28
    v_max_f32 v29, 0, v29
    v_mul_f32 v28, v28, v36
    v_mul_f32 v29, v29, v37
    v_lshlrev_b32 v30, 16, v21
    v_and_b32 v31, 0xffff0000, v21
    v_lshlrev_b32 v36, 16, v25
    v_and_b32 v37, 0xffff0000, v25
    v_max_f32 v30, 0, v30
    v_max_f32 v31, 0, v31
    v_mul_f32 v30, v30, v36
    v_mul_f32 v31, v31, v37
    v_lshlrev_b32 v32, 16, v22
    v_and_b32 v33, 0xffff0000, v22
    v_lshlrev_b32 v36, 16, v26
    v_and_b32 v37, 0xffff0000, v26
    v_max_f32 v32, 0, v32
    v_max_f32 v33, 0, v33
    v_mul_f32 v32, v32, v36
    v_mul_f32 v33, v33, v37
    v_lshlrev_b32 v34, 16, v23
    v_and_b32 v35, 0xffff0000, v23
    v_lshlrev_b32 v36, 16, v27
    v_and_b32 v37, 0xffff0000, v27
    v_max_f32 v34, 0, v34
    v_max_f32 v35, 0, v35
    v_mul_f32 v34, v34, v36
    v_mul_f32 v35, v35, v37
    v_cvt_pk_bf16_f32 v20, v28, v29
    v_cvt_pk_bf16_f32 v21, v30, v31
    v_cvt_pk_bf16_f32 v22, v32, v33
    v_cvt_pk_bf16_f32 v23, v34, v35
    ds_write_b64 v6, v[20:21] offset:64
    ds_write_b64 v6, v[22:23] offset:80
    v_cvt_pk_bf16_f32 v20, v180, v181
    v_cvt_pk_bf16_f32 v21, v182, v183
    v_cvt_pk_bf16_f32 v22, v184, v185
    v_cvt_pk_bf16_f32 v23, v186, v187
    v_cvt_pk_bf16_f32 v24, v188, v189
    v_cvt_pk_bf16_f32 v25, v190, v191
    v_cvt_pk_bf16_f32 v26, v192, v193
    v_cvt_pk_bf16_f32 v27, v194, v195
    s_nop 0
    v_lshlrev_b32 v28, 16, v20
    v_and_b32 v29, 0xffff0000, v20
    v_lshlrev_b32 v36, 16, v24
    v_and_b32 v37, 0xffff0000, v24
    v_max_f32 v28, 0, v28
    v_max_f32 v29, 0, v29
    v_mul_f32 v28, v28, v36
    v_mul_f32 v29, v29, v37
    v_lshlrev_b32 v30, 16, v21
    v_and_b32 v31, 0xffff0000, v21
    v_lshlrev_b32 v36, 16, v25
    v_and_b32 v37, 0xffff0000, v25
    v_max_f32 v30, 0, v30
    v_max_f32 v31, 0, v31
    v_mul_f32 v30, v30, v36
    v_mul_f32 v31, v31, v37
    v_lshlrev_b32 v32, 16, v22
    v_and_b32 v33, 0xffff0000, v22
    v_lshlrev_b32 v36, 16, v26
    v_and_b32 v37, 0xffff0000, v26
    v_max_f32 v32, 0, v32
    v_max_f32 v33, 0, v33
    v_mul_f32 v32, v32, v36
    v_mul_f32 v33, v33, v37
    v_lshlrev_b32 v34, 16, v23
    v_and_b32 v35, 0xffff0000, v23
    v_lshlrev_b32 v36, 16, v27
    v_and_b32 v37, 0xffff0000, v27
    v_max_f32 v34, 0, v34
    v_max_f32 v35, 0, v35
    v_mul_f32 v34, v34, v36
    v_mul_f32 v35, v35, v37
    v_cvt_pk_bf16_f32 v20, v28, v29
    v_cvt_pk_bf16_f32 v21, v30, v31
    v_cvt_pk_bf16_f32 v22, v32, v33
    v_cvt_pk_bf16_f32 v23, v34, v35
    ds_write_b64 v6, v[20:21] offset:12864
    ds_write_b64 v6, v[22:23] offset:12880
    s_waitcnt lgkmcnt(0)
    s_barrier
    s_add_u32 s6, s6, 16777216
    s_addc_u32 s7, s7, 0
    s_mov_b32 s48, s6
    s_and_b32 s49, s7, 0xffff
    s_mov_b32 s50, 9699328
    s_mov_b32 s51, 0x20000
    v_add_u32 v8, 0, v2
    v_mul_u32_u24 v9, 0xaaab, v8
    v_lshrrev_b32 v9, 19, v9
    v_mul_u32_u24 v10, 12, v9
    v_sub_u32 v10, v8, v10
    s_lshl_b32 s54, s17, 5
    v_add_u32 v9, s54, v9
    v_mul_u32_u24 v11, 400, v9
    v_lshl_add_u32 v11, v10, 4, v11
    ds_read_b128 v[20:23], v11
    s_lshl_b32 s54, s14, 8
    v_add_u32 v9, s54, v9
    v_mul_u32_u24 v9, 4736, v9
    v_lshl_add_u32 v9, v10, 4, v9
    s_sub_u32 s52, s15, 10
    s_mul_i32 s52, s52, 192
    s_add_u32 s52, s52, 1280
    s_waitcnt lgkmcnt(0)
    buffer_store_dwordx4 v[20:23], v9, s[48:51], s52 offen
    v_add_u32 v8, 64, v2
    v_mul_u32_u24 v9, 0xaaab, v8
    v_lshrrev_b32 v9, 19, v9
    v_mul_u32_u24 v10, 12, v9
    v_sub_u32 v10, v8, v10
    s_lshl_b32 s54, s17, 5
    v_add_u32 v9, s54, v9
    v_mul_u32_u24 v11, 400, v9
    v_lshl_add_u32 v11, v10, 4, v11
    ds_read_b128 v[20:23], v11
    s_lshl_b32 s54, s14, 8
    v_add_u32 v9, s54, v9
    v_mul_u32_u24 v9, 4736, v9
    v_lshl_add_u32 v9, v10, 4, v9
    s_sub_u32 s52, s15, 10
    s_mul_i32 s52, s52, 192
    s_add_u32 s52, s52, 1280
    s_waitcnt lgkmcnt(0)
    buffer_store_dwordx4 v[20:23], v9, s[48:51], s52 offen
    v_add_u32 v8, 128, v2
    v_mul_u32_u24 v9, 0xaaab, v8
    v_lshrrev_b32 v9, 19, v9
    v_mul_u32_u24 v10, 12, v9
    v_sub_u32 v10, v8, v10
    s_lshl_b32 s54, s17, 5
    v_add_u32 v9, s54, v9
    v_mul_u32_u24 v11, 400, v9
    v_lshl_add_u32 v11, v10, 4, v11
    ds_read_b128 v[20:23], v11
    s_lshl_b32 s54, s14, 8
    v_add_u32 v9, s54, v9
    v_mul_u32_u24 v9, 4736, v9
    v_lshl_add_u32 v9, v10, 4, v9
    s_sub_u32 s52, s15, 10
    s_mul_i32 s52, s52, 192
    s_add_u32 s52, s52, 1280
    s_waitcnt lgkmcnt(0)
    buffer_store_dwordx4 v[20:23], v9, s[48:51], s52 offen
    v_add_u32 v8, 192, v2
    v_mul_u32_u24 v9, 0xaaab, v8
    v_lshrrev_b32 v9, 19, v9
    v_mul_u32_u24 v10, 12, v9
    v_sub_u32 v10, v8, v10
    s_lshl_b32 s54, s17, 5
    v_add_u32 v9, s54, v9
    v_mul_u32_u24 v11, 400, v9
    v_lshl_add_u32 v11, v10, 4, v11
    ds_read_b128 v[20:23], v11
    s_lshl_b32 s54, s14, 8
    v_add_u32 v9, s54, v9
    v_mul_u32_u24 v9, 4736, v9
    v_lshl_add_u32 v9, v10, 4, v9
    s_sub_u32 s52, s15, 10
    s_mul_i32 s52, s52, 192
    s_add_u32 s52, s52, 1280
    s_waitcnt lgkmcnt(0)
    buffer_store_dwordx4 v[20:23], v9, s[48:51], s52 offen
    v_add_u32 v8, 256, v2
    v_mul_u32_u24 v9, 0xaaab, v8
    v_lshrrev_b32 v9, 19, v9
    v_mul_u32_u24 v10, 12, v9
    v_sub_u32 v10, v8, v10
    s_lshl_b32 s54, s17, 5
    v_add_u32 v9, s54, v9
    v_mul_u32_u24 v11, 400, v9
    v_lshl_add_u32 v11, v10, 4, v11
    ds_read_b128 v[20:23], v11
    s_lshl_b32 s54, s14, 8
    v_add_u32 v9, s54, v9
    v_mul_u32_u24 v9, 4736, v9
    v_lshl_add_u32 v9, v10, 4, v9
    s_sub_u32 s52, s15, 10
    s_mul_i32 s52, s52, 192
    s_add_u32 s52, s52, 1280
    s_waitcnt lgkmcnt(0)
    buffer_store_dwordx4 v[20:23], v9, s[48:51], s52 offen
    v_add_u32 v8, 320, v2
    v_mul_u32_u24 v9, 0xaaab, v8
    v_lshrrev_b32 v9, 19, v9
    v_mul_u32_u24 v10, 12, v9
    v_sub_u32 v10, v8, v10
    s_lshl_b32 s54, s17, 5
    v_add_u32 v9, s54, v9
    v_mul_u32_u24 v11, 400, v9
    v_lshl_add_u32 v11, v10, 4, v11
    ds_read_b128 v[20:23], v11
    s_lshl_b32 s54, s14, 8
    v_add_u32 v9, s54, v9
    v_mul_u32_u24 v9, 4736, v9
    v_lshl_add_u32 v9, v10, 4, v9
    s_sub_u32 s52, s15, 10
    s_mul_i32 s52, s52, 192
    s_add_u32 s52, s52, 1280
    s_waitcnt lgkmcnt(0)
    buffer_store_dwordx4 v[20:23], v9, s[48:51], s52 offen
g1_end:
    s_waitcnt vmcnt(0)
g1_done:
    s_endpgm
.globl attn_kernel
.p2align 8
.type attn_kernel,@function
attn_kernel:
    s_cmp_ge_u32 s2, 256
    s_cbranch_scc1 at_done
    s_load_dwordx2 s[6:7], s[0:1], 72
    s_lshl_b32 s3, s2, 8
    v_add_u32 v1, s3, v0
    v_and_b32 v2, 31, v1
    v_lshrrev_b32 v3, 5, v1
    v_mul_u32_u24 v4, 40, v2
    s_waitcnt lgkmcnt(0)
    s_add_u32 s8, s6, 4194304
    s_addc_u32 s9, s7, 0
    s_mov_b32 s12, s8
    s_and_b32 s13, s9, 0xffff
    s_mov_b32 s14, 7864320
    s_mov_b32 s15, 0x20000
    s_add_u32 s8, s6, 16777216
    s_addc_u32 s9, s7, 0
    s_mov_b32 s16, s8
    s_and_b32 s17, s9, 0xffff
    s_mov_b32 s18, 9699328
    s_mov_b32 s19, 0x20000
    v_mul_u32_u24 v5, 0xf00, v3
    v_add_u32 v5, v5, v4
    buffer_load_dwordx2 v[20:21], v5, s[12:15], 0 offen offset:0
    buffer_load_dwordx2 v[22:23], v5, s[12:15], 0 offen offset:8
    buffer_load_dwordx2 v[24:25], v5, s[12:15], 0 offen offset:16
    buffer_load_dwordx2 v[26:27], v5, s[12:15], 0 offen offset:24
    buffer_load_dwordx2 v[28:29], v5, s[12:15], 0 offen offset:32
    v_subrev_u32 v6, 0, v3
    v_max_i32 v6, 0, v6
    v_mul_u32_u24 v6, 0xf00, v6
    v_add_u32 v6, v6, v4
    buffer_load_dwordx2 v[32:33], v6, s[12:15], 0 offen offset:1280
    buffer_load_dwordx2 v[34:35], v6, s[12:15], 0 offen offset:1288
    buffer_load_dwordx2 v[36:37], v6, s[12:15], 0 offen offset:1296
    buffer_load_dwordx2 v[38:39], v6, s[12:15], 0 offen offset:1304
    buffer_load_dwordx2 v[40:41], v6, s[12:15], 0 offen offset:1312
    buffer_load_dwordx2 v[112:113], v6, s[12:15], 0 offen offset:2560
    buffer_load_dwordx2 v[114:115], v6, s[12:15], 0 offen offset:2568
    buffer_load_dwordx2 v[116:117], v6, s[12:15], 0 offen offset:2576
    buffer_load_dwordx2 v[118:119], v6, s[12:15], 0 offen offset:2584
    buffer_load_dwordx2 v[120:121], v6, s[12:15], 0 offen offset:2592
    v_subrev_u32 v6, 2, v3
    v_max_i32 v6, 0, v6
    v_mul_u32_u24 v6, 0xf00, v6
    v_add_u32 v6, v6, v4
    buffer_load_dwordx2 v[42:43], v6, s[12:15], 0 offen offset:1280
    buffer_load_dwordx2 v[44:45], v6, s[12:15], 0 offen offset:1288
    buffer_load_dwordx2 v[46:47], v6, s[12:15], 0 offen offset:1296
    buffer_load_dwordx2 v[48:49], v6, s[12:15], 0 offen offset:1304
    buffer_load_dwordx2 v[50:51], v6, s[12:15], 0 offen offset:1312
    buffer_load_dwordx2 v[122:123], v6, s[12:15], 0 offen offset:2560
    buffer_load_dwordx2 v[124:125], v6, s[12:15], 0 offen offset:2568
    buffer_load_dwordx2 v[126:127], v6, s[12:15], 0 offen offset:2576
    buffer_load_dwordx2 v[128:129], v6, s[12:15], 0 offen offset:2584
    buffer_load_dwordx2 v[130:131], v6, s[12:15], 0 offen offset:2592
    v_subrev_u32 v6, 4, v3
    v_max_i32 v6, 0, v6
    v_mul_u32_u24 v6, 0xf00, v6
    v_add_u32 v6, v6, v4
    buffer_load_dwordx2 v[52:53], v6, s[12:15], 0 offen offset:1280
    buffer_load_dwordx2 v[54:55], v6, s[12:15], 0 offen offset:1288
    buffer_load_dwordx2 v[56:57], v6, s[12:15], 0 offen offset:1296
    buffer_load_dwordx2 v[58:59], v6, s[12:15], 0 offen offset:1304
    buffer_load_dwordx2 v[60:61], v6, s[12:15], 0 offen offset:1312
    buffer_load_dwordx2 v[132:133], v6, s[12:15], 0 offen offset:2560
    buffer_load_dwordx2 v[134:135], v6, s[12:15], 0 offen offset:2568
    buffer_load_dwordx2 v[136:137], v6, s[12:15], 0 offen offset:2576
    buffer_load_dwordx2 v[138:139], v6, s[12:15], 0 offen offset:2584
    buffer_load_dwordx2 v[140:141], v6, s[12:15], 0 offen offset:2592
    v_subrev_u32 v6, 6, v3
    v_max_i32 v6, 0, v6
    v_mul_u32_u24 v6, 0xf00, v6
    v_add_u32 v6, v6, v4
    buffer_load_dwordx2 v[62:63], v6, s[12:15], 0 offen offset:1280
    buffer_load_dwordx2 v[64:65], v6, s[12:15], 0 offen offset:1288
    buffer_load_dwordx2 v[66:67], v6, s[12:15], 0 offen offset:1296
    buffer_load_dwordx2 v[68:69], v6, s[12:15], 0 offen offset:1304
    buffer_load_dwordx2 v[70:71], v6, s[12:15], 0 offen offset:1312
    buffer_load_dwordx2 v[142:143], v6, s[12:15], 0 offen offset:2560
    buffer_load_dwordx2 v[144:145], v6, s[12:15], 0 offen offset:2568
    buffer_load_dwordx2 v[146:147], v6, s[12:15], 0 offen offset:2576
    buffer_load_dwordx2 v[148:149], v6, s[12:15], 0 offen offset:2584
    buffer_load_dwordx2 v[150:151], v6, s[12:15], 0 offen offset:2592
    v_subrev_u32 v6, 8, v3
    v_max_i32 v6, 0, v6
    v_mul_u32_u24 v6, 0xf00, v6
    v_add_u32 v6, v6, v4
    buffer_load_dwordx2 v[72:73], v6, s[12:15], 0 offen offset:1280
    buffer_load_dwordx2 v[74:75], v6, s[12:15], 0 offen offset:1288
    buffer_load_dwordx2 v[76:77], v6, s[12:15], 0 offen offset:1296
    buffer_load_dwordx2 v[78:79], v6, s[12:15], 0 offen offset:1304
    buffer_load_dwordx2 v[80:81], v6, s[12:15], 0 offen offset:1312
    buffer_load_dwordx2 v[152:153], v6, s[12:15], 0 offen offset:2560
    buffer_load_dwordx2 v[154:155], v6, s[12:15], 0 offen offset:2568
    buffer_load_dwordx2 v[156:157], v6, s[12:15], 0 offen offset:2576
    buffer_load_dwordx2 v[158:159], v6, s[12:15], 0 offen offset:2584
    buffer_load_dwordx2 v[160:161], v6, s[12:15], 0 offen offset:2592
    v_subrev_u32 v6, 10, v3
    v_max_i32 v6, 0, v6
    v_mul_u32_u24 v6, 0xf00, v6
    v_add_u32 v6, v6, v4
    buffer_load_dwordx2 v[82:83], v6, s[12:15], 0 offen offset:1280
    buffer_load_dwordx2 v[84:85], v6, s[12:15], 0 offen offset:1288
    buffer_load_dwordx2 v[86:87], v6, s[12:15], 0 offen offset:1296
    buffer_load_dwordx2 v[88:89], v6, s[12:15], 0 offen offset:1304
    buffer_load_dwordx2 v[90:91], v6, s[12:15], 0 offen offset:1312
    buffer_load_dwordx2 v[162:163], v6, s[12:15], 0 offen offset:2560
    buffer_load_dwordx2 v[164:165], v6, s[12:15], 0 offen offset:2568
    buffer_load_dwordx2 v[166:167], v6, s[12:15], 0 offen offset:2576
    buffer_load_dwordx2 v[168:169], v6, s[12:15], 0 offen offset:2584
    buffer_load_dwordx2 v[170:171], v6, s[12:15], 0 offen offset:2592
    v_subrev_u32 v6, 12, v3
    v_max_i32 v6, 0, v6
    v_mul_u32_u24 v6, 0xf00, v6
    v_add_u32 v6, v6, v4
    buffer_load_dwordx2 v[92:93], v6, s[12:15], 0 offen offset:1280
    buffer_load_dwordx2 v[94:95], v6, s[12:15], 0 offen offset:1288
    buffer_load_dwordx2 v[96:97], v6, s[12:15], 0 offen offset:1296
    buffer_load_dwordx2 v[98:99], v6, s[12:15], 0 offen offset:1304
    buffer_load_dwordx2 v[100:101], v6, s[12:15], 0 offen offset:1312
    buffer_load_dwordx2 v[172:173], v6, s[12:15], 0 offen offset:2560
    buffer_load_dwordx2 v[174:175], v6, s[12:15], 0 offen offset:2568
    buffer_load_dwordx2 v[176:177], v6, s[12:15], 0 offen offset:2576
    buffer_load_dwordx2 v[178:179], v6, s[12:15], 0 offen offset:2584
    buffer_load_dwordx2 v[180:181], v6, s[12:15], 0 offen offset:2592
    v_subrev_u32 v6, 14, v3
    v_max_i32 v6, 0, v6
    v_mul_u32_u24 v6, 0xf00, v6
    v_add_u32 v6, v6, v4
    buffer_load_dwordx2 v[102:103], v6, s[12:15], 0 offen offset:1280
    buffer_load_dwordx2 v[104:105], v6, s[12:15], 0 offen offset:1288
    buffer_load_dwordx2 v[106:107], v6, s[12:15], 0 offen offset:1296
    buffer_load_dwordx2 v[108:109], v6, s[12:15], 0 offen offset:1304
    buffer_load_dwordx2 v[110:111], v6, s[12:15], 0 offen offset:1312
    buffer_load_dwordx2 v[182:183], v6, s[12:15], 0 offen offset:2560
    buffer_load_dwordx2 v[184:185], v6, s[12:15], 0 offen offset:2568
    buffer_load_dwordx2 v[186:187], v6, s[12:15], 0 offen offset:2576
    buffer_load_dwordx2 v[188:189], v6, s[12:15], 0 offen offset:2584
    buffer_load_dwordx2 v[190:191], v6, s[12:15], 0 offen offset:2592
    s_waitcnt vmcnt(0)
    v_mov_b32 v192, 0
    v_dot2_f32_bf16 v192, v20, v32, v192
    v_dot2_f32_bf16 v192, v21, v33, v192
    v_dot2_f32_bf16 v192, v22, v34, v192
    v_dot2_f32_bf16 v192, v23, v35, v192
    v_dot2_f32_bf16 v192, v24, v36, v192
    v_dot2_f32_bf16 v192, v25, v37, v192
    v_dot2_f32_bf16 v192, v26, v38, v192
    v_dot2_f32_bf16 v192, v27, v39, v192
    v_dot2_f32_bf16 v192, v28, v40, v192
    v_dot2_f32_bf16 v192, v29, v41, v192
    v_mov_b32 v193, 0
    v_dot2_f32_bf16 v193, v20, v42, v193
    v_dot2_f32_bf16 v193, v21, v43, v193
    v_dot2_f32_bf16 v193, v22, v44, v193
    v_dot2_f32_bf16 v193, v23, v45, v193
    v_dot2_f32_bf16 v193, v24, v46, v193
    v_dot2_f32_bf16 v193, v25, v47, v193
    v_dot2_f32_bf16 v193, v26, v48, v193
    v_dot2_f32_bf16 v193, v27, v49, v193
    v_dot2_f32_bf16 v193, v28, v50, v193
    v_dot2_f32_bf16 v193, v29, v51, v193
    v_mov_b32 v194, 0
    v_dot2_f32_bf16 v194, v20, v52, v194
    v_dot2_f32_bf16 v194, v21, v53, v194
    v_dot2_f32_bf16 v194, v22, v54, v194
    v_dot2_f32_bf16 v194, v23, v55, v194
    v_dot2_f32_bf16 v194, v24, v56, v194
    v_dot2_f32_bf16 v194, v25, v57, v194
    v_dot2_f32_bf16 v194, v26, v58, v194
    v_dot2_f32_bf16 v194, v27, v59, v194
    v_dot2_f32_bf16 v194, v28, v60, v194
    v_dot2_f32_bf16 v194, v29, v61, v194
    v_mov_b32 v195, 0
    v_dot2_f32_bf16 v195, v20, v62, v195
    v_dot2_f32_bf16 v195, v21, v63, v195
    v_dot2_f32_bf16 v195, v22, v64, v195
    v_dot2_f32_bf16 v195, v23, v65, v195
    v_dot2_f32_bf16 v195, v24, v66, v195
    v_dot2_f32_bf16 v195, v25, v67, v195
    v_dot2_f32_bf16 v195, v26, v68, v195
    v_dot2_f32_bf16 v195, v27, v69, v195
    v_dot2_f32_bf16 v195, v28, v70, v195
    v_dot2_f32_bf16 v195, v29, v71, v195
    v_mov_b32 v196, 0
    v_dot2_f32_bf16 v196, v20, v72, v196
    v_dot2_f32_bf16 v196, v21, v73, v196
    v_dot2_f32_bf16 v196, v22, v74, v196
    v_dot2_f32_bf16 v196, v23, v75, v196
    v_dot2_f32_bf16 v196, v24, v76, v196
    v_dot2_f32_bf16 v196, v25, v77, v196
    v_dot2_f32_bf16 v196, v26, v78, v196
    v_dot2_f32_bf16 v196, v27, v79, v196
    v_dot2_f32_bf16 v196, v28, v80, v196
    v_dot2_f32_bf16 v196, v29, v81, v196
    v_mov_b32 v197, 0
    v_dot2_f32_bf16 v197, v20, v82, v197
    v_dot2_f32_bf16 v197, v21, v83, v197
    v_dot2_f32_bf16 v197, v22, v84, v197
    v_dot2_f32_bf16 v197, v23, v85, v197
    v_dot2_f32_bf16 v197, v24, v86, v197
    v_dot2_f32_bf16 v197, v25, v87, v197
    v_dot2_f32_bf16 v197, v26, v88, v197
    v_dot2_f32_bf16 v197, v27, v89, v197
    v_dot2_f32_bf16 v197, v28, v90, v197
    v_dot2_f32_bf16 v197, v29, v91, v197
    v_mov_b32 v198, 0
    v_dot2_f32_bf16 v198, v20, v92, v198
    v_dot2_f32_bf16 v198, v21, v93, v198
    v_dot2_f32_bf16 v198, v22, v94, v198
    v_dot2_f32_bf16 v198, v23, v95, v198
    v_dot2_f32_bf16 v198, v24, v96, v198
    v_dot2_f32_bf16 v198, v25, v97, v198
    v_dot2_f32_bf16 v198, v26, v98, v198
    v_dot2_f32_bf16 v198, v27, v99, v198
    v_dot2_f32_bf16 v198, v28, v100, v198
    v_dot2_f32_bf16 v198, v29, v101, v198
    v_mov_b32 v199, 0
    v_dot2_f32_bf16 v199, v20, v102, v199
    v_dot2_f32_bf16 v199, v21, v103, v199
    v_dot2_f32_bf16 v199, v22, v104, v199
    v_dot2_f32_bf16 v199, v23, v105, v199
    v_dot2_f32_bf16 v199, v24, v106, v199
    v_dot2_f32_bf16 v199, v25, v107, v199
    v_dot2_f32_bf16 v199, v26, v108, v199
    v_dot2_f32_bf16 v199, v27, v109, v199
    v_dot2_f32_bf16 v199, v28, v110, v199
    v_dot2_f32_bf16 v199, v29, v111, v199
    v_cvt_pk_bf16_f32 v200, v192, v193
    v_cvt_pk_bf16_f32 v201, v194, v195
    v_cvt_pk_bf16_f32 v202, v196, v197
    v_cvt_pk_bf16_f32 v203, v198, v199
    s_nop 0
    v_lshlrev_b32 v192, 16, v200
    v_and_b32 v193, 0xffff0000, v200
    v_lshlrev_b32 v194, 16, v201
    v_and_b32 v195, 0xffff0000, v201
    v_lshlrev_b32 v196, 16, v202
    v_and_b32 v197, 0xffff0000, v202
    v_lshlrev_b32 v198, 16, v203
    v_and_b32 v199, 0xffff0000, v203
    v_mul_f32 v192, 0x3e64f92e, v192
    v_mul_f32 v193, 0x3e64f92e, v193
    v_mul_f32 v194, 0x3e64f92e, v194
    v_mul_f32 v195, 0x3e64f92e, v195
    v_mul_f32 v196, 0x3e64f92e, v196
    v_mul_f32 v197, 0x3e64f92e, v197
    v_mul_f32 v198, 0x3e64f92e, v198
    v_mul_f32 v199, 0x3e64f92e, v199
    v_cvt_pk_bf16_f32 v200, v192, v193
    v_cvt_pk_bf16_f32 v201, v194, v195
    v_cvt_pk_bf16_f32 v202, v196, v197
    v_cvt_pk_bf16_f32 v203, v198, v199
    s_nop 0
    v_lshlrev_b32 v192, 16, v200
    v_and_b32 v193, 0xffff0000, v200
    v_lshlrev_b32 v194, 16, v201
    v_and_b32 v195, 0xffff0000, v201
    v_lshlrev_b32 v196, 16, v202
    v_and_b32 v197, 0xffff0000, v202
    v_lshlrev_b32 v198, 16, v203
    v_and_b32 v199, 0xffff0000, v203
    v_cmp_gt_u32 vcc, 2, v3
    s_nop 1
    v_mov_b32 v7, 0xce6e6b28
    v_cndmask_b32 v193, v193, v7, vcc
    v_cmp_gt_u32 vcc, 4, v3
    s_nop 1
    v_mov_b32 v7, 0xce6e6b28
    v_cndmask_b32 v194, v194, v7, vcc
    v_cmp_gt_u32 vcc, 6, v3
    s_nop 1
    v_mov_b32 v7, 0xce6e6b28
    v_cndmask_b32 v195, v195, v7, vcc
    v_cmp_gt_u32 vcc, 8, v3
    s_nop 1
    v_mov_b32 v7, 0xce6e6b28
    v_cndmask_b32 v196, v196, v7, vcc
    v_cmp_gt_u32 vcc, 10, v3
    s_nop 1
    v_mov_b32 v7, 0xce6e6b28
    v_cndmask_b32 v197, v197, v7, vcc
    v_cmp_gt_u32 vcc, 12, v3
    s_nop 1
    v_mov_b32 v7, 0xce6e6b28
    v_cndmask_b32 v198, v198, v7, vcc
    v_cmp_gt_u32 vcc, 14, v3
    s_nop 1
    v_mov_b32 v7, 0xce6e6b28
    v_cndmask_b32 v199, v199, v7, vcc
    v_max_f32 v8, v192, v193
    v_max_f32 v8, v8, v194
    v_max_f32 v8, v8, v195
    v_max_f32 v8, v8, v196
    v_max_f32 v8, v8, v197
    v_max_f32 v8, v8, v198
    v_max_f32 v8, v8, v199
    v_mov_b32 v9, 0
    v_sub_f32 v192, v192, v8
    v_mul_f32 v192, 0x3fb8aa3b, v192
    v_exp_f32 v192, v192
    v_sub_f32 v193, v193, v8
    v_mul_f32 v193, 0x3fb8aa3b, v193
    v_exp_f32 v193, v193
    v_sub_f32 v194, v194, v8
    v_mul_f32 v194, 0x3fb8aa3b, v194
    v_exp_f32 v194, v194
    v_sub_f32 v195, v195, v8
    v_mul_f32 v195, 0x3fb8aa3b, v195
    v_exp_f32 v195, v195
    v_sub_f32 v196, v196, v8
    v_mul_f32 v196, 0x3fb8aa3b, v196
    v_exp_f32 v196, v196
    v_sub_f32 v197, v197, v8
    v_mul_f32 v197, 0x3fb8aa3b, v197
    v_exp_f32 v197, v197
    v_sub_f32 v198, v198, v8
    v_mul_f32 v198, 0x3fb8aa3b, v198
    v_exp_f32 v198, v198
    v_sub_f32 v199, v199, v8
    v_mul_f32 v199, 0x3fb8aa3b, v199
    v_exp_f32 v199, v199
    s_nop 1
    v_add_f32 v9, v9, v192
    v_add_f32 v9, v9, v193
    v_add_f32 v9, v9, v194
    v_add_f32 v9, v9, v195
    v_add_f32 v9, v9, v196
    v_add_f32 v9, v9, v197
    v_add_f32 v9, v9, v198
    v_add_f32 v9, v9, v199
    v_rcp_f32 v9, v9
    s_nop 1
    v_mul_f32 v192, v192, v9
    v_mul_f32 v193, v193, v9
    v_mul_f32 v194, v194, v9
    v_mul_f32 v195, v195, v9
    v_mul_f32 v196, v196, v9
    v_mul_f32 v197, v197, v9
    v_mul_f32 v198, v198, v9
    v_mul_f32 v199, v199, v9
    v_cvt_pk_bf16_f32 v200, v192, v193
    v_cvt_pk_bf16_f32 v201, v194, v195
    v_cvt_pk_bf16_f32 v202, v196, v197
    v_cvt_pk_bf16_f32 v203, v198, v199
    s_nop 0
    v_lshlrev_b32 v192, 16, v200
    v_and_b32 v193, 0xffff0000, v200
    v_lshlrev_b32 v194, 16, v201
    v_and_b32 v195, 0xffff0000, v201
    v_lshlrev_b32 v196, 16, v202
    v_and_b32 v197, 0xffff0000, v202
    v_lshlrev_b32 v198, 16, v203
    v_and_b32 v199, 0xffff0000, v203
    v_mov_b32 v204, 0
    v_mov_b32 v205, 0
    v_mov_b32 v206, 0
    v_mov_b32 v207, 0
    v_mov_b32 v208, 0
    v_mov_b32 v209, 0
    v_mov_b32 v210, 0
    v_mov_b32 v211, 0
    v_mov_b32 v212, 0
    v_mov_b32 v213, 0
    v_mov_b32 v214, 0
    v_mov_b32 v215, 0
    v_mov_b32 v216, 0
    v_mov_b32 v217, 0
    v_mov_b32 v218, 0
    v_mov_b32 v219, 0
    v_mov_b32 v220, 0
    v_mov_b32 v221, 0
    v_mov_b32 v222, 0
    v_mov_b32 v223, 0
    v_lshlrev_b32 v10, 16, v112
    v_and_b32 v11, 0xffff0000, v112
    v_fmac_f32 v204, v192, v10
    v_fmac_f32 v205, v192, v11
    v_lshlrev_b32 v10, 16, v113
    v_and_b32 v11, 0xffff0000, v113
    v_fmac_f32 v206, v192, v10
    v_fmac_f32 v207, v192, v11
    v_lshlrev_b32 v10, 16, v114
    v_and_b32 v11, 0xffff0000, v114
    v_fmac_f32 v208, v192, v10
    v_fmac_f32 v209, v192, v11
    v_lshlrev_b32 v10, 16, v115
    v_and_b32 v11, 0xffff0000, v115
    v_fmac_f32 v210, v192, v10
    v_fmac_f32 v211, v192, v11
    v_lshlrev_b32 v10, 16, v116
    v_and_b32 v11, 0xffff0000, v116
    v_fmac_f32 v212, v192, v10
    v_fmac_f32 v213, v192, v11
    v_lshlrev_b32 v10, 16, v117
    v_and_b32 v11, 0xffff0000, v117
    v_fmac_f32 v214, v192, v10
    v_fmac_f32 v215, v192, v11
    v_lshlrev_b32 v10, 16, v118
    v_and_b32 v11, 0xffff0000, v118
    v_fmac_f32 v216, v192, v10
    v_fmac_f32 v217, v192, v11
    v_lshlrev_b32 v10, 16, v119
    v_and_b32 v11, 0xffff0000, v119
    v_fmac_f32 v218, v192, v10
    v_fmac_f32 v219, v192, v11
    v_lshlrev_b32 v10, 16, v120
    v_and_b32 v11, 0xffff0000, v120
    v_fmac_f32 v220, v192, v10
    v_fmac_f32 v221, v192, v11
    v_lshlrev_b32 v10, 16, v121
    v_and_b32 v11, 0xffff0000, v121
    v_fmac_f32 v222, v192, v10
    v_fmac_f32 v223, v192, v11
    v_lshlrev_b32 v10, 16, v122
    v_and_b32 v11, 0xffff0000, v122
    v_fmac_f32 v204, v193, v10
    v_fmac_f32 v205, v193, v11
    v_lshlrev_b32 v10, 16, v123
    v_and_b32 v11, 0xffff0000, v123
    v_fmac_f32 v206, v193, v10
    v_fmac_f32 v207, v193, v11
    v_lshlrev_b32 v10, 16, v124
    v_and_b32 v11, 0xffff0000, v124
    v_fmac_f32 v208, v193, v10
    v_fmac_f32 v209, v193, v11
    v_lshlrev_b32 v10, 16, v125
    v_and_b32 v11, 0xffff0000, v125
    v_fmac_f32 v210, v193, v10
    v_fmac_f32 v211, v193, v11
    v_lshlrev_b32 v10, 16, v126
    v_and_b32 v11, 0xffff0000, v126
    v_fmac_f32 v212, v193, v10
    v_fmac_f32 v213, v193, v11
    v_lshlrev_b32 v10, 16, v127
    v_and_b32 v11, 0xffff0000, v127
    v_fmac_f32 v214, v193, v10
    v_fmac_f32 v215, v193, v11
    v_lshlrev_b32 v10, 16, v128
    v_and_b32 v11, 0xffff0000, v128
    v_fmac_f32 v216, v193, v10
    v_fmac_f32 v217, v193, v11
    v_lshlrev_b32 v10, 16, v129
    v_and_b32 v11, 0xffff0000, v129
    v_fmac_f32 v218, v193, v10
    v_fmac_f32 v219, v193, v11
    v_lshlrev_b32 v10, 16, v130
    v_and_b32 v11, 0xffff0000, v130
    v_fmac_f32 v220, v193, v10
    v_fmac_f32 v221, v193, v11
    v_lshlrev_b32 v10, 16, v131
    v_and_b32 v11, 0xffff0000, v131
    v_fmac_f32 v222, v193, v10
    v_fmac_f32 v223, v193, v11
    v_lshlrev_b32 v10, 16, v132
    v_and_b32 v11, 0xffff0000, v132
    v_fmac_f32 v204, v194, v10
    v_fmac_f32 v205, v194, v11
    v_lshlrev_b32 v10, 16, v133
    v_and_b32 v11, 0xffff0000, v133
    v_fmac_f32 v206, v194, v10
    v_fmac_f32 v207, v194, v11
    v_lshlrev_b32 v10, 16, v134
    v_and_b32 v11, 0xffff0000, v134
    v_fmac_f32 v208, v194, v10
    v_fmac_f32 v209, v194, v11
    v_lshlrev_b32 v10, 16, v135
    v_and_b32 v11, 0xffff0000, v135
    v_fmac_f32 v210, v194, v10
    v_fmac_f32 v211, v194, v11
    v_lshlrev_b32 v10, 16, v136
    v_and_b32 v11, 0xffff0000, v136
    v_fmac_f32 v212, v194, v10
    v_fmac_f32 v213, v194, v11
    v_lshlrev_b32 v10, 16, v137
    v_and_b32 v11, 0xffff0000, v137
    v_fmac_f32 v214, v194, v10
    v_fmac_f32 v215, v194, v11
    v_lshlrev_b32 v10, 16, v138
    v_and_b32 v11, 0xffff0000, v138
    v_fmac_f32 v216, v194, v10
    v_fmac_f32 v217, v194, v11
    v_lshlrev_b32 v10, 16, v139
    v_and_b32 v11, 0xffff0000, v139
    v_fmac_f32 v218, v194, v10
    v_fmac_f32 v219, v194, v11
    v_lshlrev_b32 v10, 16, v140
    v_and_b32 v11, 0xffff0000, v140
    v_fmac_f32 v220, v194, v10
    v_fmac_f32 v221, v194, v11
    v_lshlrev_b32 v10, 16, v141
    v_and_b32 v11, 0xffff0000, v141
    v_fmac_f32 v222, v194, v10
    v_fmac_f32 v223, v194, v11
    v_lshlrev_b32 v10, 16, v142
    v_and_b32 v11, 0xffff0000, v142
    v_fmac_f32 v204, v195, v10
    v_fmac_f32 v205, v195, v11
    v_lshlrev_b32 v10, 16, v143
    v_and_b32 v11, 0xffff0000, v143
    v_fmac_f32 v206, v195, v10
    v_fmac_f32 v207, v195, v11
    v_lshlrev_b32 v10, 16, v144
    v_and_b32 v11, 0xffff0000, v144
    v_fmac_f32 v208, v195, v10
    v_fmac_f32 v209, v195, v11
    v_lshlrev_b32 v10, 16, v145
    v_and_b32 v11, 0xffff0000, v145
    v_fmac_f32 v210, v195, v10
    v_fmac_f32 v211, v195, v11
    v_lshlrev_b32 v10, 16, v146
    v_and_b32 v11, 0xffff0000, v146
    v_fmac_f32 v212, v195, v10
    v_fmac_f32 v213, v195, v11
    v_lshlrev_b32 v10, 16, v147
    v_and_b32 v11, 0xffff0000, v147
    v_fmac_f32 v214, v195, v10
    v_fmac_f32 v215, v195, v11
    v_lshlrev_b32 v10, 16, v148
    v_and_b32 v11, 0xffff0000, v148
    v_fmac_f32 v216, v195, v10
    v_fmac_f32 v217, v195, v11
    v_lshlrev_b32 v10, 16, v149
    v_and_b32 v11, 0xffff0000, v149
    v_fmac_f32 v218, v195, v10
    v_fmac_f32 v219, v195, v11
    v_lshlrev_b32 v10, 16, v150
    v_and_b32 v11, 0xffff0000, v150
    v_fmac_f32 v220, v195, v10
    v_fmac_f32 v221, v195, v11
    v_lshlrev_b32 v10, 16, v151
    v_and_b32 v11, 0xffff0000, v151
    v_fmac_f32 v222, v195, v10
    v_fmac_f32 v223, v195, v11
    v_lshlrev_b32 v10, 16, v152
    v_and_b32 v11, 0xffff0000, v152
    v_fmac_f32 v204, v196, v10
    v_fmac_f32 v205, v196, v11
    v_lshlrev_b32 v10, 16, v153
    v_and_b32 v11, 0xffff0000, v153
    v_fmac_f32 v206, v196, v10
    v_fmac_f32 v207, v196, v11
    v_lshlrev_b32 v10, 16, v154
    v_and_b32 v11, 0xffff0000, v154
    v_fmac_f32 v208, v196, v10
    v_fmac_f32 v209, v196, v11
    v_lshlrev_b32 v10, 16, v155
    v_and_b32 v11, 0xffff0000, v155
    v_fmac_f32 v210, v196, v10
    v_fmac_f32 v211, v196, v11
    v_lshlrev_b32 v10, 16, v156
    v_and_b32 v11, 0xffff0000, v156
    v_fmac_f32 v212, v196, v10
    v_fmac_f32 v213, v196, v11
    v_lshlrev_b32 v10, 16, v157
    v_and_b32 v11, 0xffff0000, v157
    v_fmac_f32 v214, v196, v10
    v_fmac_f32 v215, v196, v11
    v_lshlrev_b32 v10, 16, v158
    v_and_b32 v11, 0xffff0000, v158
    v_fmac_f32 v216, v196, v10
    v_fmac_f32 v217, v196, v11
    v_lshlrev_b32 v10, 16, v159
    v_and_b32 v11, 0xffff0000, v159
    v_fmac_f32 v218, v196, v10
    v_fmac_f32 v219, v196, v11
    v_lshlrev_b32 v10, 16, v160
    v_and_b32 v11, 0xffff0000, v160
    v_fmac_f32 v220, v196, v10
    v_fmac_f32 v221, v196, v11
    v_lshlrev_b32 v10, 16, v161
    v_and_b32 v11, 0xffff0000, v161
    v_fmac_f32 v222, v196, v10
    v_fmac_f32 v223, v196, v11
    v_lshlrev_b32 v10, 16, v162
    v_and_b32 v11, 0xffff0000, v162
    v_fmac_f32 v204, v197, v10
    v_fmac_f32 v205, v197, v11
    v_lshlrev_b32 v10, 16, v163
    v_and_b32 v11, 0xffff0000, v163
    v_fmac_f32 v206, v197, v10
    v_fmac_f32 v207, v197, v11
    v_lshlrev_b32 v10, 16, v164
    v_and_b32 v11, 0xffff0000, v164
    v_fmac_f32 v208, v197, v10
    v_fmac_f32 v209, v197, v11
    v_lshlrev_b32 v10, 16, v165
    v_and_b32 v11, 0xffff0000, v165
    v_fmac_f32 v210, v197, v10
    v_fmac_f32 v211, v197, v11
    v_lshlrev_b32 v10, 16, v166
    v_and_b32 v11, 0xffff0000, v166
    v_fmac_f32 v212, v197, v10
    v_fmac_f32 v213, v197, v11
    v_lshlrev_b32 v10, 16, v167
    v_and_b32 v11, 0xffff0000, v167
    v_fmac_f32 v214, v197, v10
    v_fmac_f32 v215, v197, v11
    v_lshlrev_b32 v10, 16, v168
    v_and_b32 v11, 0xffff0000, v168
    v_fmac_f32 v216, v197, v10
    v_fmac_f32 v217, v197, v11
    v_lshlrev_b32 v10, 16, v169
    v_and_b32 v11, 0xffff0000, v169
    v_fmac_f32 v218, v197, v10
    v_fmac_f32 v219, v197, v11
    v_lshlrev_b32 v10, 16, v170
    v_and_b32 v11, 0xffff0000, v170
    v_fmac_f32 v220, v197, v10
    v_fmac_f32 v221, v197, v11
    v_lshlrev_b32 v10, 16, v171
    v_and_b32 v11, 0xffff0000, v171
    v_fmac_f32 v222, v197, v10
    v_fmac_f32 v223, v197, v11
    v_lshlrev_b32 v10, 16, v172
    v_and_b32 v11, 0xffff0000, v172
    v_fmac_f32 v204, v198, v10
    v_fmac_f32 v205, v198, v11
    v_lshlrev_b32 v10, 16, v173
    v_and_b32 v11, 0xffff0000, v173
    v_fmac_f32 v206, v198, v10
    v_fmac_f32 v207, v198, v11
    v_lshlrev_b32 v10, 16, v174
    v_and_b32 v11, 0xffff0000, v174
    v_fmac_f32 v208, v198, v10
    v_fmac_f32 v209, v198, v11
    v_lshlrev_b32 v10, 16, v175
    v_and_b32 v11, 0xffff0000, v175
    v_fmac_f32 v210, v198, v10
    v_fmac_f32 v211, v198, v11
    v_lshlrev_b32 v10, 16, v176
    v_and_b32 v11, 0xffff0000, v176
    v_fmac_f32 v212, v198, v10
    v_fmac_f32 v213, v198, v11
    v_lshlrev_b32 v10, 16, v177
    v_and_b32 v11, 0xffff0000, v177
    v_fmac_f32 v214, v198, v10
    v_fmac_f32 v215, v198, v11
    v_lshlrev_b32 v10, 16, v178
    v_and_b32 v11, 0xffff0000, v178
    v_fmac_f32 v216, v198, v10
    v_fmac_f32 v217, v198, v11
    v_lshlrev_b32 v10, 16, v179
    v_and_b32 v11, 0xffff0000, v179
    v_fmac_f32 v218, v198, v10
    v_fmac_f32 v219, v198, v11
    v_lshlrev_b32 v10, 16, v180
    v_and_b32 v11, 0xffff0000, v180
    v_fmac_f32 v220, v198, v10
    v_fmac_f32 v221, v198, v11
    v_lshlrev_b32 v10, 16, v181
    v_and_b32 v11, 0xffff0000, v181
    v_fmac_f32 v222, v198, v10
    v_fmac_f32 v223, v198, v11
    v_lshlrev_b32 v10, 16, v182
    v_and_b32 v11, 0xffff0000, v182
    v_fmac_f32 v204, v199, v10
    v_fmac_f32 v205, v199, v11
    v_lshlrev_b32 v10, 16, v183
    v_and_b32 v11, 0xffff0000, v183
    v_fmac_f32 v206, v199, v10
    v_fmac_f32 v207, v199, v11
    v_lshlrev_b32 v10, 16, v184
    v_and_b32 v11, 0xffff0000, v184
    v_fmac_f32 v208, v199, v10
    v_fmac_f32 v209, v199, v11
    v_lshlrev_b32 v10, 16, v185
    v_and_b32 v11, 0xffff0000, v185
    v_fmac_f32 v210, v199, v10
    v_fmac_f32 v211, v199, v11
    v_lshlrev_b32 v10, 16, v186
    v_and_b32 v11, 0xffff0000, v186
    v_fmac_f32 v212, v199, v10
    v_fmac_f32 v213, v199, v11
    v_lshlrev_b32 v10, 16, v187
    v_and_b32 v11, 0xffff0000, v187
    v_fmac_f32 v214, v199, v10
    v_fmac_f32 v215, v199, v11
    v_lshlrev_b32 v10, 16, v188
    v_and_b32 v11, 0xffff0000, v188
    v_fmac_f32 v216, v199, v10
    v_fmac_f32 v217, v199, v11
    v_lshlrev_b32 v10, 16, v189
    v_and_b32 v11, 0xffff0000, v189
    v_fmac_f32 v218, v199, v10
    v_fmac_f32 v219, v199, v11
    v_lshlrev_b32 v10, 16, v190
    v_and_b32 v11, 0xffff0000, v190
    v_fmac_f32 v220, v199, v10
    v_fmac_f32 v221, v199, v11
    v_lshlrev_b32 v10, 16, v191
    v_and_b32 v11, 0xffff0000, v191
    v_fmac_f32 v222, v199, v10
    v_fmac_f32 v223, v199, v11
    v_cvt_pk_bf16_f32 v20, v204, v205
    v_cvt_pk_bf16_f32 v21, v206, v207
    v_cvt_pk_bf16_f32 v22, v208, v209
    v_cvt_pk_bf16_f32 v23, v210, v211
    v_cvt_pk_bf16_f32 v24, v212, v213
    v_cvt_pk_bf16_f32 v25, v214, v215
    v_cvt_pk_bf16_f32 v26, v216, v217
    v_cvt_pk_bf16_f32 v27, v218, v219
    v_cvt_pk_bf16_f32 v28, v220, v221
    v_cvt_pk_bf16_f32 v29, v222, v223
    v_mul_u32_u24 v5, 4736, v3
    v_add_u32 v5, v5, v4
    buffer_store_dwordx2 v[20:21], v5, s[16:19], 0 offen offset:0
    buffer_store_dwordx2 v[22:23], v5, s[16:19], 0 offen offset:8
    buffer_store_dwordx2 v[24:25], v5, s[16:19], 0 offen offset:16
    buffer_store_dwordx2 v[26:27], v5, s[16:19], 0 offen offset:24
    buffer_store_dwordx2 v[28:29], v5, s[16:19], 0 offen offset:32
    s_waitcnt vmcnt(0)
at_done:
    s_endpgm
.globl gemm2_kernel
.p2align 8
.type gemm2_kernel,@function
gemm2_kernel:
    s_cmp_ge_u32 s2, 256
    s_cbranch_scc1 g2_done
    s_load_dwordx2 s[4:5], s[0:1], 16
    s_load_dwordx2 s[8:9], s[0:1], 48
    s_load_dwordx2 s[6:7], s[0:1], 72
    s_load_dwordx2 s[10:11], s[0:1], 0
    s_load_dwordx2 s[56:57], s[0:1], 56
    s_and_b32 s12, s2, 7
    s_lshr_b32 s13, s2, 3
    s_lshr_b32 s14, s12, 1
    s_lshl_b32 s14, s14, 3
    s_and_b32 s15, s13, 7
    s_add_u32 s14, s14, s15
    s_and_b32 s15, s12, 1
    s_lshl_b32 s15, s15, 2
    s_lshr_b32 s16, s13, 3
    s_add_u32 s15, s15, s16
    v_lshrrev_b32 v1, 6, v0
    s_nop 0
    v_readfirstlane_b32 s17, v1
    v_and_b32 v2, 63, v0
    s_waitcnt lgkmcnt(0)
    s_add_u32 s6, s6, 16777216
    s_addc_u32 s7, s7, 0
    s_mov_b32 s20, s6
    s_and_b32 s21, s7, 0xffff
    s_mov_b32 s22, 9699328
    s_mov_b32 s23, 0x20000
    s_mov_b32 s24, s4
    s_and_b32 s25, s5, 0xffff
    s_mov_b32 s26, 819200
    s_mov_b32 s27, 0x20000
    s_mov_b32 s28, s8
    s_and_b32 s29, s9, 0xffff
    s_mov_b32 s30, 2211840
    s_mov_b32 s31, 0x20000
    v_lshrrev_b32 v6, 4, v2
    v_add_u32 v6, 0, v6
    v_and_b32 v6, 7, v6
    v_and_b32 v7, 7, v2
    v_xor_b32 v7, v7, v6
    v_lshrrev_b32 v8, 3, v2
    v_mul_u32_u24 v8, 4736, v8
    v_lshl_add_u32 v3, v7, 4, v8
    v_lshrrev_b32 v6, 4, v2
    v_add_u32 v6, 4, v6
    v_and_b32 v6, 7, v6
    v_and_b32 v7, 7, v2
    v_xor_b32 v7, v7, v6
    v_lshrrev_b32 v8, 3, v2
    v_mul_u32_u24 v8, 4736, v8
    v_lshl_add_u32 v4, v7, 4, v8
    s_lshl_b32 s34, s14, 6
    s_lshl_b32 s35, s17, 4
    s_add_u32 s35, s34, s35
    s_mul_i32 s32, s35, 4736
    s_add_u32 s33, s32, 36864
    v_add_u32 v10, 0, v2
    v_mul_u32_u24 v11, 0xaaab, v10
    v_lshrrev_b32 v11, 19, v11
    v_mul_u32_u24 v12, 12, v11
    v_sub_u32 v12, v10, v12
    v_lshrrev_b32 v13, 1, v12
    v_lshrrev_b32 v14, 3, v11
    v_and_b32 v14, 1, v14
    v_xor_b32 v13, v13, v14
    v_min_u32 v13, 4, v13
    v_and_b32 v12, 1, v12
    v_lshlrev_b32 v13, 5, v13
    v_lshl_add_u32 v13, v12, 4, v13
    v_mul_u32_u24 v11, 0x500, v11
    v_add_u32 v13, v13, v11
    v_subrev_u32 v5, 0, v13
    v_add_u32 v10, 64, v2
    v_mul_u32_u24 v11, 0xaaab, v10
    v_lshrrev_b32 v11, 19, v11
    v_mul_u32_u24 v12, 12, v11
    v_sub_u32 v12, v10, v12
    v_lshrrev_b32 v13, 1, v12
    v_lshrrev_b32 v14, 3, v11
    v_and_b32 v14, 1, v14
    v_xor_b32 v13, v13, v14
    v_min_u32 v13, 4, v13
    v_and_b32 v12, 1, v12
    v_lshlrev_b32 v13, 5, v13
    v_lshl_add_u32 v13, v12, 4, v13
    v_mul_u32_u24 v11, 0x500, v11
    v_add_u32 v13, v13, v11
    v_subrev_u32 v6, 1024, v13
    v_add_u32 v10, 128, v2
    v_mul_u32_u24 v11, 0xaaab, v10
    v_lshrrev_b32 v11, 19, v11
    v_mul_u32_u24 v12, 12, v11
    v_sub_u32 v12, v10, v12
    v_lshrrev_b32 v13, 1, v12
    v_lshrrev_b32 v14, 3, v11
    v_and_b32 v14, 1, v14
    v_xor_b32 v13, v13, v14
    v_min_u32 v13, 4, v13
    v_and_b32 v12, 1, v12
    v_lshlrev_b32 v13, 5, v13
    v_lshl_add_u32 v13, v12, 4, v13
    v_mul_u32_u24 v11, 0x500, v11
    v_add_u32 v13, v13, v11
    v_subrev_u32 v7, 2048, v13
    s_mul_i32 s60, s15, 160
    s_mul_i32 s36, s17, 0x5000
    s_add_u32 s36, s36, s60
    s_lshl_b32 s37, s17, 11
    s_mul_i32 s38, s17, 3072
    s_add_u32 s38, s38, 8192
    v_and_b32 v12, 15, v2
    v_add_u32 v12, s35, v12
    v_subrev_u32 v12, s34, v12
    v_lshrrev_b32 v13, 1, v12
    v_and_b32 v13, 7, v13
    v_lshrrev_b32 v14, 4, v2
    v_add_u32 v15, 0, v14
    v_xor_b32 v15, v15, v13
    v_lshlrev_b32 v15, 4, v15
    v_lshl_add_u32 v10, v12, 7, v15
    v_add_u32 v15, 4, v14
    v_xor_b32 v15, v15, v13
    v_lshlrev_b32 v15, 4, v15
    v_lshl_add_u32 v11, v12, 7, v15
    v_lshrrev_b32 v14, 4, v2
    v_lshlrev_b32 v15, 3, v14
    v_and_b32 v16, 15, v2
    v_lshrrev_b32 v17, 2, v16
    v_add_u32 v15, v15, v17
    v_mul_u32_u24 v15, 192, v15
    v_and_b32 v16, 3, v16
    v_lshl_add_u32 v15, v16, 3, v15
    v_add_u32 v15, 8192, v15
    v_and_b32 v14, 1, v14
    v_lshlrev_b32 v14, 5, v14
    v_add_u32 v12, v15, v14
    v_sub_u32 v13, v15, v14
    v_add_u32 v30, 61440, v10
    v_add_u32 v31, 61440, v11
    v_add_u32 v32, 61440, v12
    v_add_u32 v33, 61440, v13
    v_mov_b32 v100, 0
    v_mov_b32 v101, 0
    v_mov_b32 v102, 0
    v_mov_b32 v103, 0
    v_mov_b32 v104, 0
    v_mov_b32 v105, 0
    v_mov_b32 v106, 0
    v_mov_b32 v107, 0
    v_mov_b32 v108, 0
    v_mov_b32 v109, 0
    v_mov_b32 v110, 0
    v_mov_b32 v111, 0
    v_mov_b32 v112, 0
    v_mov_b32 v113, 0
    v_mov_b32 v114, 0
    v_mov_b32 v115, 0
    v_mov_b32 v116, 0
    v_mov_b32 v117, 0
    v_mov_b32 v118, 0
    v_mov_b32 v119, 0
    s_add_u32 m0, s37, 0
    s_add_u32 s39, s32, 0
    s_add_u32 s40, s33, 0
    buffer_load_dwordx4 v3, s[20:23], s39 offen lds
    buffer_load_dwordx4 v4, s[20:23], s40 offen offset:1024 lds
    s_add_u32 m0, s38, 0
    s_add_u32 s39, s36, 0
    buffer_load_dwordx4 v5, s[24:27], s39 offen offset:0 lds
    buffer_load_dwordx4 v6, s[24:27], s39 offen offset:1024 lds
    buffer_load_dwordx4 v7, s[24:27], s39 offen offset:2048 lds
    s_add_u32 m0, s37, 20480
    s_add_u32 s39, s32, 128
    s_add_u32 s40, s33, 128
    buffer_load_dwordx4 v3, s[20:23], s39 offen lds
    buffer_load_dwordx4 v4, s[20:23], s40 offen offset:1024 lds
    s_add_u32 m0, s38, 20480
    s_add_u32 s39, s36, 81920
    buffer_load_dwordx4 v5, s[24:27], s39 offen offset:0 lds
    buffer_load_dwordx4 v6, s[24:27], s39 offen offset:1024 lds
    buffer_load_dwordx4 v7, s[24:27], s39 offen offset:2048 lds
    s_add_u32 m0, s37, 40960
    s_add_u32 s39, s32, 256
    s_add_u32 s40, s33, 256
    buffer_load_dwordx4 v3, s[20:23], s39 offen lds
    buffer_load_dwordx4 v4, s[20:23], s40 offen offset:1024 lds
    s_add_u32 m0, s38, 40960
    s_add_u32 s39, s36, 163840
    buffer_load_dwordx4 v5, s[24:27], s39 offen offset:0 lds
    buffer_load_dwordx4 v6, s[24:27], s39 offen offset:1024 lds
    buffer_load_dwordx4 v7, s[24:27], s39 offen offset:2048 lds
    s_add_u32 m0, s37, 61440
    s_add_u32 s39, s32, 384
    s_add_u32 s40, s33, 384
    buffer_load_dwordx4 v3, s[20:23], s39 offen lds
    buffer_load_dwordx4 v4, s[20:23], s40 offen offset:1024 lds
    s_add_u32 m0, s38, 61440
    s_add_u32 s39, s36, 245760
    buffer_load_dwordx4 v5, s[24:27], s39 offen offset:0 lds
    buffer_load_dwordx4 v6, s[24:27], s39 offen offset:1024 lds
    buffer_load_dwordx4 v7, s[24:27], s39 offen offset:2048 lds
    s_add_u32 m0, s37, 81920
    s_add_u32 s39, s32, 512
    s_add_u32 s40, s33, 512
    buffer_load_dwordx4 v3, s[20:23], s39 offen lds
    buffer_load_dwordx4 v4, s[20:23], s40 offen offset:1024 lds
    s_add_u32 m0, s38, 81920
    s_add_u32 s39, s36, 327680
    buffer_load_dwordx4 v5, s[24:27], s39 offen offset:0 lds
    buffer_load_dwordx4 v6, s[24:27], s39 offen offset:1024 lds
    buffer_load_dwordx4 v7, s[24:27], s39 offen offset:2048 lds
    s_waitcnt vmcnt(20)
    s_barrier
    s_add_u32 m0, s37, 102400
    s_add_u32 s39, s32, 640
    s_add_u32 s40, s33, 640
    buffer_load_dwordx4 v3, s[20:23], s39 offen lds
    buffer_load_dwordx4 v4, s[20:23], s40 offen offset:1024 lds
    s_add_u32 m0, s38, 102400
    s_add_u32 s39, s36, 409600
    buffer_load_dwordx4 v5, s[24:27], s39 offen offset:0 lds
    buffer_load_dwordx4 v6, s[24:27], s39 offen offset:1024 lds
    buffer_load_dwordx4 v7, s[24:27], s39 offen offset:2048 lds
    ds_read_b128 v[40:43], v10 offset:0
    ds_read_b64_tr_b16 v[48:49], v12 offset:0
    ds_read_b64_tr_b16 v[50:51], v12 offset:768
    ds_read_b64_tr_b16 v[52:53], v13 offset:32
    ds_read_b64_tr_b16 v[54:55], v13 offset:800
    ds_read_b64_tr_b16 v[56:57], v12 offset:64
    ds_read_b64_tr_b16 v[58:59], v12 offset:832
    ds_read_b64_tr_b16 v[60:61], v13 offset:96
    ds_read_b64_tr_b16 v[62:63], v13 offset:864
    ds_read_b64_tr_b16 v[64:65], v12 offset:128
    ds_read_b64_tr_b16 v[66:67], v12 offset:896
    ds_read_b128 v[44:47], v11 offset:0
    ds_read_b64_tr_b16 v[68:69], v12 offset:6144
    ds_read_b64_tr_b16 v[70:71], v12 offset:6912
    ds_read_b64_tr_b16 v[72:73], v13 offset:6176
    ds_read_b64_tr_b16 v[74:75], v13 offset:6944
    ds_read_b64_tr_b16 v[76:77], v12 offset:6208
    ds_read_b64_tr_b16 v[78:79], v12 offset:6976
    ds_read_b64_tr_b16 v[80:81], v13 offset:6240
    ds_read_b64_tr_b16 v[82:83], v13 offset:7008
    ds_read_b64_tr_b16 v[84:85], v12 offset:6272
    ds_read_b64_tr_b16 v[86:87], v12 offset:7040
    s_waitcnt lgkmcnt(11)
    v_mfma_f32_16x16x32_bf16 v[100:103], v[48:51], v[40:43], v[100:103]
    v_mfma_f32_16x16x32_bf16 v[104:107], v[52:55], v[40:43], v[104:107]
    v_mfma_f32_16x16x32_bf16 v[108:111], v[56:59], v[40:43], v[108:111]
    v_mfma_f32_16x16x32_bf16 v[112:115], v[60:63], v[40:43], v[112:115]
    v_mfma_f32_16x16x32_bf16 v[116:119], v[64:67], v[40:43], v[116:119]
    s_waitcnt lgkmcnt(0)
    v_mfma_f32_16x16x32_bf16 v[100:103], v[68:71], v[44:47], v[100:103]
    v_mfma_f32_16x16x32_bf16 v[104:107], v[72:75], v[44:47], v[104:107]
    v_mfma_f32_16x16x32_bf16 v[108:111], v[76:79], v[44:47], v[108:111]
    v_mfma_f32_16x16x32_bf16 v[112:115], v[80:83], v[44:47], v[112:115]
    v_mfma_f32_16x16x32_bf16 v[116:119], v[84:87], v[44:47], v[116:119]
    s_waitcnt vmcnt(20)
    s_barrier
    s_add_u32 m0, s37, 0
    s_add_u32 s39, s32, 768
    s_add_u32 s40, s33, 768
    buffer_load_dwordx4 v3, s[20:23], s39 offen lds
    buffer_load_dwordx4 v4, s[20:23], s40 offen offset:1024 lds
    s_add_u32 m0, s38, 0
    s_add_u32 s39, s36, 491520
    buffer_load_dwordx4 v5, s[24:27], s39 offen offset:0 lds
    buffer_load_dwordx4 v6, s[24:27], s39 offen offset:1024 lds
    buffer_load_dwordx4 v7, s[24:27], s39 offen offset:2048 lds
    ds_read_b128 v[40:43], v10 offset:20480
    ds_read_b64_tr_b16 v[48:49], v12 offset:20480
    ds_read_b64_tr_b16 v[50:51], v12 offset:21248
    ds_read_b64_tr_b16 v[52:53], v13 offset:20512
    ds_read_b64_tr_b16 v[54:55], v13 offset:21280
    ds_read_b64_tr_b16 v[56:57], v12 offset:20544
    ds_read_b64_tr_b16 v[58:59], v12 offset:21312
    ds_read_b64_tr_b16 v[60:61], v13 offset:20576
    ds_read_b64_tr_b16 v[62:63], v13 offset:21344
    ds_read_b64_tr_b16 v[64:65], v12 offset:20608
    ds_read_b64_tr_b16 v[66:67], v12 offset:21376
    ds_read_b128 v[44:47], v11 offset:20480
    ds_read_b64_tr_b16 v[68:69], v12 offset:26624
    ds_read_b64_tr_b16 v[70:71], v12 offset:27392
    ds_read_b64_tr_b16 v[72:73], v13 offset:26656
    ds_read_b64_tr_b16 v[74:75], v13 offset:27424
    ds_read_b64_tr_b16 v[76:77], v12 offset:26688
    ds_read_b64_tr_b16 v[78:79], v12 offset:27456
    ds_read_b64_tr_b16 v[80:81], v13 offset:26720
    ds_read_b64_tr_b16 v[82:83], v13 offset:27488
    ds_read_b64_tr_b16 v[84:85], v12 offset:26752
    ds_read_b64_tr_b16 v[86:87], v12 offset:27520
    s_waitcnt lgkmcnt(11)
    v_mfma_f32_16x16x32_bf16 v[100:103], v[48:51], v[40:43], v[100:103]
    v_mfma_f32_16x16x32_bf16 v[104:107], v[52:55], v[40:43], v[104:107]
    v_mfma_f32_16x16x32_bf16 v[108:111], v[56:59], v[40:43], v[108:111]
    v_mfma_f32_16x16x32_bf16 v[112:115], v[60:63], v[40:43], v[112:115]
    v_mfma_f32_16x16x32_bf16 v[116:119], v[64:67], v[40:43], v[116:119]
    s_waitcnt lgkmcnt(0)
    v_mfma_f32_16x16x32_bf16 v[100:103], v[68:71], v[44:47], v[100:103]
    v_mfma_f32_16x16x32_bf16 v[104:107], v[72:75], v[44:47], v[104:107]
    v_mfma_f32_16x16x32_bf16 v[108:111], v[76:79], v[44:47], v[108:111]
    v_mfma_f32_16x16x32_bf16 v[112:115], v[80:83], v[44:47], v[112:115]
    v_mfma_f32_16x16x32_bf16 v[116:119], v[84:87], v[44:47], v[116:119]
    s_waitcnt vmcnt(20)
    s_barrier
    s_add_u32 m0, s37, 20480
    s_add_u32 s39, s32, 896
    s_add_u32 s40, s33, 896
    buffer_load_dwordx4 v3, s[20:23], s39 offen lds
    buffer_load_dwordx4 v4, s[20:23], s40 offen offset:1024 lds
    s_add_u32 m0, s38, 20480
    s_add_u32 s39, s36, 573440
    buffer_load_dwordx4 v5, s[24:27], s39 offen offset:0 lds
    buffer_load_dwordx4 v6, s[24:27], s39 offen offset:1024 lds
    buffer_load_dwordx4 v7, s[24:27], s39 offen offset:2048 lds
    ds_read_b128 v[40:43], v10 offset:40960
    ds_read_b64_tr_b16 v[48:49], v12 offset:40960
    ds_read_b64_tr_b16 v[50:51], v12 offset:41728
    ds_read_b64_tr_b16 v[52:53], v13 offset:40992
    ds_read_b64_tr_b16 v[54:55], v13 offset:41760
    ds_read_b64_tr_b16 v[56:57], v12 offset:41024
    ds_read_b64_tr_b16 v[58:59], v12 offset:41792
    ds_read_b64_tr_b16 v[60:61], v13 offset:41056
    ds_read_b64_tr_b16 v[62:63], v13 offset:41824
    ds_read_b64_tr_b16 v[64:65], v12 offset:41088
    ds_read_b64_tr_b16 v[66:67], v12 offset:41856
    ds_read_b128 v[44:47], v11 offset:40960
    ds_read_b64_tr_b16 v[68:69], v12 offset:47104
    ds_read_b64_tr_b16 v[70:71], v12 offset:47872
    ds_read_b64_tr_b16 v[72:73], v13 offset:47136
    ds_read_b64_tr_b16 v[74:75], v13 offset:47904
    ds_read_b64_tr_b16 v[76:77], v12 offset:47168
    ds_read_b64_tr_b16 v[78:79], v12 offset:47936
    ds_read_b64_tr_b16 v[80:81], v13 offset:47200
    ds_read_b64_tr_b16 v[82:83], v13 offset:47968
    ds_read_b64_tr_b16 v[84:85], v12 offset:47232
    ds_read_b64_tr_b16 v[86:87], v12 offset:48000
    s_waitcnt lgkmcnt(11)
    v_mfma_f32_16x16x32_bf16 v[100:103], v[48:51], v[40:43], v[100:103]
    v_mfma_f32_16x16x32_bf16 v[104:107], v[52:55], v[40:43], v[104:107]
    v_mfma_f32_16x16x32_bf16 v[108:111], v[56:59], v[40:43], v[108:111]
    v_mfma_f32_16x16x32_bf16 v[112:115], v[60:63], v[40:43], v[112:115]
    v_mfma_f32_16x16x32_bf16 v[116:119], v[64:67], v[40:43], v[116:119]
    s_waitcnt lgkmcnt(0)
    v_mfma_f32_16x16x32_bf16 v[100:103], v[68:71], v[44:47], v[100:103]
    v_mfma_f32_16x16x32_bf16 v[104:107], v[72:75], v[44:47], v[104:107]
    v_mfma_f32_16x16x32_bf16 v[108:111], v[76:79], v[44:47], v[108:111]
    v_mfma_f32_16x16x32_bf16 v[112:115], v[80:83], v[44:47], v[112:115]
    v_mfma_f32_16x16x32_bf16 v[116:119], v[84:87], v[44:47], v[116:119]
    s_waitcnt vmcnt(20)
    s_barrier
    s_add_u32 m0, s37, 40960
    s_add_u32 s39, s32, 1024
    s_add_u32 s40, s33, 1024
    buffer_load_dwordx4 v3, s[20:23], s39 offen lds
    buffer_load_dwordx4 v4, s[20:23], s40 offen offset:1024 lds
    s_add_u32 m0, s38, 40960
    s_add_u32 s39, s36, 655360
    buffer_load_dwordx4 v5, s[24:27], s39 offen offset:0 lds
    buffer_load_dwordx4 v6, s[24:27], s39 offen offset:1024 lds
    buffer_load_dwordx4 v7, s[24:27], s39 offen offset:2048 lds
    ds_read_b128 v[40:43], v30 offset:0
    ds_read_b64_tr_b16 v[48:49], v32 offset:0
    ds_read_b64_tr_b16 v[50:51], v32 offset:768
    ds_read_b64_tr_b16 v[52:53], v33 offset:32
    ds_read_b64_tr_b16 v[54:55], v33 offset:800
    ds_read_b64_tr_b16 v[56:57], v32 offset:64
    ds_read_b64_tr_b16 v[58:59], v32 offset:832
    ds_read_b64_tr_b16 v[60:61], v33 offset:96
    ds_read_b64_tr_b16 v[62:63], v33 offset:864
    ds_read_b64_tr_b16 v[64:65], v32 offset:128
    ds_read_b64_tr_b16 v[66:67], v32 offset:896
    ds_read_b128 v[44:47], v31 offset:0
    ds_read_b64_tr_b16 v[68:69], v32 offset:6144
    ds_read_b64_tr_b16 v[70:71], v32 offset:6912
    ds_read_b64_tr_b16 v[72:73], v33 offset:6176
    ds_read_b64_tr_b16 v[74:75], v33 offset:6944
    ds_read_b64_tr_b16 v[76:77], v32 offset:6208
    ds_read_b64_tr_b16 v[78:79], v32 offset:6976
    ds_read_b64_tr_b16 v[80:81], v33 offset:6240
    ds_read_b64_tr_b16 v[82:83], v33 offset:7008
    ds_read_b64_tr_b16 v[84:85], v32 offset:6272
    ds_read_b64_tr_b16 v[86:87], v32 offset:7040
    s_waitcnt lgkmcnt(11)
    v_mfma_f32_16x16x32_bf16 v[100:103], v[48:51], v[40:43], v[100:103]
    v_mfma_f32_16x16x32_bf16 v[104:107], v[52:55], v[40:43], v[104:107]
    v_mfma_f32_16x16x32_bf16 v[108:111], v[56:59], v[40:43], v[108:111]
    v_mfma_f32_16x16x32_bf16 v[112:115], v[60:63], v[40:43], v[112:115]
    v_mfma_f32_16x16x32_bf16 v[116:119], v[64:67], v[40:43], v[116:119]
    s_waitcnt lgkmcnt(0)
    v_mfma_f32_16x16x32_bf16 v[100:103], v[68:71], v[44:47], v[100:103]
    v_mfma_f32_16x16x32_bf16 v[104:107], v[72:75], v[44:47], v[104:107]
    v_mfma_f32_16x16x32_bf16 v[108:111], v[76:79], v[44:47], v[108:111]
    v_mfma_f32_16x16x32_bf16 v[112:115], v[80:83], v[44:47], v[112:115]
    v_mfma_f32_16x16x32_bf16 v[116:119], v[84:87], v[44:47], v[116:119]
    s_waitcnt vmcnt(20)
    s_barrier
    s_add_u32 m0, s37, 61440
    s_add_u32 s39, s32, 1152
    s_add_u32 s40, s33, 1152
    buffer_load_dwordx4 v3, s[20:23], s39 offen lds
    buffer_load_dwordx4 v4, s[20:23], s40 offen offset:1024 lds
    s_add_u32 m0, s38, 61440
    s_add_u32 s39, s36, 737280
    buffer_load_dwordx4 v5, s[24:27], s39 offen offset:0 lds
    buffer_load_dwordx4 v6, s[24:27], s39 offen offset:1024 lds
    buffer_load_dwordx4 v7, s[24:27], s39 offen offset:2048 lds
    ds_read_b128 v[40:43], v30 offset:20480
    ds_read_b64_tr_b16 v[48:49], v32 offset:20480
    ds_read_b64_tr_b16 v[50:51], v32 offset:21248
    ds_read_b64_tr_b16 v[52:53], v33 offset:20512
    ds_read_b64_tr_b16 v[54:55], v33 offset:21280
    ds_read_b64_tr_b16 v[56:57], v32 offset:20544
    ds_read_b64_tr_b16 v[58:59], v32 offset:21312
    ds_read_b64_tr_b16 v[60:61], v33 offset:20576
    ds_read_b64_tr_b16 v[62:63], v33 offset:21344
    ds_read_b64_tr_b16 v[64:65], v32 offset:20608
    ds_read_b64_tr_b16 v[66:67], v32 offset:21376
    ds_read_b128 v[44:47], v31 offset:20480
    ds_read_b64_tr_b16 v[68:69], v32 offset:26624
    ds_read_b64_tr_b16 v[70:71], v32 offset:27392
    ds_read_b64_tr_b16 v[72:73], v33 offset:26656
    ds_read_b64_tr_b16 v[74:75], v33 offset:27424
    ds_read_b64_tr_b16 v[76:77], v32 offset:26688
    ds_read_b64_tr_b16 v[78:79], v32 offset:27456
    ds_read_b64_tr_b16 v[80:81], v33 offset:26720
    ds_read_b64_tr_b16 v[82:83], v33 offset:27488
    ds_read_b64_tr_b16 v[84:85], v32 offset:26752
    ds_read_b64_tr_b16 v[86:87], v32 offset:27520
    s_waitcnt lgkmcnt(11)
    v_mfma_f32_16x16x32_bf16 v[100:103], v[48:51], v[40:43], v[100:103]
    v_mfma_f32_16x16x32_bf16 v[104:107], v[52:55], v[40:43], v[104:107]
    v_mfma_f32_16x16x32_bf16 v[108:111], v[56:59], v[40:43], v[108:111]
    v_mfma_f32_16x16x32_bf16 v[112:115], v[60:63], v[40:43], v[112:115]
    v_mfma_f32_16x16x32_bf16 v[116:119], v[64:67], v[40:43], v[116:119]
    s_waitcnt lgkmcnt(0)
    v_mfma_f32_16x16x32_bf16 v[100:103], v[68:71], v[44:47], v[100:103]
    v_mfma_f32_16x16x32_bf16 v[104:107], v[72:75], v[44:47], v[104:107]
    v_mfma_f32_16x16x32_bf16 v[108:111], v[76:79], v[44:47], v[108:111]
    v_mfma_f32_16x16x32_bf16 v[112:115], v[80:83], v[44:47], v[112:115]
    v_mfma_f32_16x16x32_bf16 v[116:119], v[84:87], v[44:47], v[116:119]
    s_waitcnt vmcnt(20)
    s_barrier
    s_add_u32 m0, s37, 81920
    s_add_u32 s39, s32, 1280
    s_add_u32 s40, s33, 1280
    buffer_load_dwordx4 v3, s[20:23], s39 offen lds
    buffer_load_dwordx4 v4, s[20:23], s40 offen offset:1024 lds
    s_add_u32 m0, s38, 81920
    s_add_u32 s39, s36, 0
    buffer_load_dwordx4 v5, s[28:31], s39 offen offset:0 lds
    buffer_load_dwordx4 v6, s[28:31], s39 offen offset:1024 lds
    buffer_load_dwordx4 v7, s[28:31], s39 offen offset:2048 lds
    ds_read_b128 v[40:43], v30 offset:40960
    ds_read_b64_tr_b16 v[48:49], v32 offset:40960
    ds_read_b64_tr_b16 v[50:51], v32 offset:41728
    ds_read_b64_tr_b16 v[52:53], v33 offset:40992
    ds_read_b64_tr_b16 v[54:55], v33 offset:41760
    ds_read_b64_tr_b16 v[56:57], v32 offset:41024
    ds_read_b64_tr_b16 v[58:59], v32 offset:41792
    ds_read_b64_tr_b16 v[60:61], v33 offset:41056
    ds_read_b64_tr_b16 v[62:63], v33 offset:41824
    ds_read_b64_tr_b16 v[64:65], v32 offset:41088
    ds_read_b64_tr_b16 v[66:67], v32 offset:41856
    ds_read_b128 v[44:47], v31 offset:40960
    ds_read_b64_tr_b16 v[68:69], v32 offset:47104
    ds_read_b64_tr_b16 v[70:71], v32 offset:47872
    ds_read_b64_tr_b16 v[72:73], v33 offset:47136
    ds_read_b64_tr_b16 v[74:75], v33 offset:47904
    ds_read_b64_tr_b16 v[76:77], v32 offset:47168
    ds_read_b64_tr_b16 v[78:79], v32 offset:47936
    ds_read_b64_tr_b16 v[80:81], v33 offset:47200
    ds_read_b64_tr_b16 v[82:83], v33 offset:47968
    ds_read_b64_tr_b16 v[84:85], v32 offset:47232
    ds_read_b64_tr_b16 v[86:87], v32 offset:48000
    s_waitcnt lgkmcnt(11)
    v_mfma_f32_16x16x32_bf16 v[100:103], v[48:51], v[40:43], v[100:103]
    v_mfma_f32_16x16x32_bf16 v[104:107], v[52:55], v[40:43], v[104:107]
    v_mfma_f32_16x16x32_bf16 v[108:111], v[56:59], v[40:43], v[108:111]
    v_mfma_f32_16x16x32_bf16 v[112:115], v[60:63], v[40:43], v[112:115]
    v_mfma_f32_16x16x32_bf16 v[116:119], v[64:67], v[40:43], v[116:119]
    s_waitcnt lgkmcnt(0)
    v_mfma_f32_16x16x32_bf16 v[100:103], v[68:71], v[44:47], v[100:103]
    v_mfma_f32_16x16x32_bf16 v[104:107], v[72:75], v[44:47], v[104:107]
    v_mfma_f32_16x16x32_bf16 v[108:111], v[76:79], v[44:47], v[108:111]
    v_mfma_f32_16x16x32_bf16 v[112:115], v[80:83], v[44:47], v[112:115]
    v_mfma_f32_16x16x32_bf16 v[116:119], v[84:87], v[44:47], v[116:119]
    s_waitcnt vmcnt(20)
    s_barrier
    s_add_u32 m0, s37, 102400
    s_add_u32 s39, s32, 1408
    s_add_u32 s40, s33, 1408
    buffer_load_dwordx4 v3, s[20:23], s39 offen lds
    buffer_load_dwordx4 v4, s[20:23], s40 offen offset:1024 lds
    s_add_u32 m0, s38, 102400
    s_add_u32 s39, s36, 81920
    buffer_load_dwordx4 v5, s[28:31], s39 offen offset:0 lds
    buffer_load_dwordx4 v6, s[28:31], s39 offen offset:1024 lds
    buffer_load_dwordx4 v7, s[28:31], s39 offen offset:2048 lds
    ds_read_b128 v[40:43], v10 offset:0
    ds_read_b64_tr_b16 v[48:49], v12 offset:0
    ds_read_b64_tr_b16 v[50:51], v12 offset:768
    ds_read_b64_tr_b16 v[52:53], v13 offset:32
    ds_read_b64_tr_b16 v[54:55], v13 offset:800
    ds_read_b64_tr_b16 v[56:57], v12 offset:64
    ds_read_b64_tr_b16 v[58:59], v12 offset:832
    ds_read_b64_tr_b16 v[60:61], v13 offset:96
    ds_read_b64_tr_b16 v[62:63], v13 offset:864
    ds_read_b64_tr_b16 v[64:65], v12 offset:128
    ds_read_b64_tr_b16 v[66:67], v12 offset:896
    ds_read_b128 v[44:47], v11 offset:0
    ds_read_b64_tr_b16 v[68:69], v12 offset:6144
    ds_read_b64_tr_b16 v[70:71], v12 offset:6912
    ds_read_b64_tr_b16 v[72:73], v13 offset:6176
    ds_read_b64_tr_b16 v[74:75], v13 offset:6944
    ds_read_b64_tr_b16 v[76:77], v12 offset:6208
    ds_read_b64_tr_b16 v[78:79], v12 offset:6976
    ds_read_b64_tr_b16 v[80:81], v13 offset:6240
    ds_read_b64_tr_b16 v[82:83], v13 offset:7008
    ds_read_b64_tr_b16 v[84:85], v12 offset:6272
    ds_read_b64_tr_b16 v[86:87], v12 offset:7040
    s_waitcnt lgkmcnt(11)
    v_mfma_f32_16x16x32_bf16 v[100:103], v[48:51], v[40:43], v[100:103]
    v_mfma_f32_16x16x32_bf16 v[104:107], v[52:55], v[40:43], v[104:107]
    v_mfma_f32_16x16x32_bf16 v[108:111], v[56:59], v[40:43], v[108:111]
    v_mfma_f32_16x16x32_bf16 v[112:115], v[60:63], v[40:43], v[112:115]
    v_mfma_f32_16x16x32_bf16 v[116:119], v[64:67], v[40:43], v[116:119]
    s_waitcnt lgkmcnt(0)
    v_mfma_f32_16x16x32_bf16 v[100:103], v[68:71], v[44:47], v[100:103]
    v_mfma_f32_16x16x32_bf16 v[104:107], v[72:75], v[44:47], v[104:107]
    v_mfma_f32_16x16x32_bf16 v[108:111], v[76:79], v[44:47], v[108:111]
    v_mfma_f32_16x16x32_bf16 v[112:115], v[80:83], v[44:47], v[112:115]
    v_mfma_f32_16x16x32_bf16 v[116:119], v[84:87], v[44:47], v[116:119]
    s_waitcnt vmcnt(20)
    s_barrier
    s_add_u32 m0, s37, 0
    s_add_u32 s39, s32, 1536
    s_add_u32 s40, s33, 1536
    buffer_load_dwordx4 v3, s[20:23], s39 offen lds
    buffer_load_dwordx4 v4, s[20:23], s40 offen offset:1024 lds
    s_add_u32 m0, s38, 0
    s_add_u32 s39, s36, 163840
    buffer_load_dwordx4 v5, s[28:31], s39 offen offset:0 lds
    buffer_load_dwordx4 v6, s[28:31], s39 offen offset:1024 lds
    buffer_load_dwordx4 v7, s[28:31], s39 offen offset:2048 lds
    ds_read_b128 v[40:43], v10 offset:20480
    ds_read_b64_tr_b16 v[48:49], v12 offset:20480
    ds_read_b64_tr_b16 v[50:51], v12 offset:21248
    ds_read_b64_tr_b16 v[52:53], v13 offset:20512
    ds_read_b64_tr_b16 v[54:55], v13 offset:21280
    ds_read_b64_tr_b16 v[56:57], v12 offset:20544
    ds_read_b64_tr_b16 v[58:59], v12 offset:21312
    ds_read_b64_tr_b16 v[60:61], v13 offset:20576
    ds_read_b64_tr_b16 v[62:63], v13 offset:21344
    ds_read_b64_tr_b16 v[64:65], v12 offset:20608
    ds_read_b64_tr_b16 v[66:67], v12 offset:21376
    ds_read_b128 v[44:47], v11 offset:20480
    ds_read_b64_tr_b16 v[68:69], v12 offset:26624
    ds_read_b64_tr_b16 v[70:71], v12 offset:27392
    ds_read_b64_tr_b16 v[72:73], v13 offset:26656
    ds_read_b64_tr_b16 v[74:75], v13 offset:27424
    ds_read_b64_tr_b16 v[76:77], v12 offset:26688
    ds_read_b64_tr_b16 v[78:79], v12 offset:27456
    ds_read_b64_tr_b16 v[80:81], v13 offset:26720
    ds_read_b64_tr_b16 v[82:83], v13 offset:27488
    ds_read_b64_tr_b16 v[84:85], v12 offset:26752
    ds_read_b64_tr_b16 v[86:87], v12 offset:27520
    s_waitcnt lgkmcnt(11)
    v_mfma_f32_16x16x32_bf16 v[100:103], v[48:51], v[40:43], v[100:103]
    v_mfma_f32_16x16x32_bf16 v[104:107], v[52:55], v[40:43], v[104:107]
    v_mfma_f32_16x16x32_bf16 v[108:111], v[56:59], v[40:43], v[108:111]
    v_mfma_f32_16x16x32_bf16 v[112:115], v[60:63], v[40:43], v[112:115]
    v_mfma_f32_16x16x32_bf16 v[116:119], v[64:67], v[40:43], v[116:119]
    s_waitcnt lgkmcnt(0)
    v_mfma_f32_16x16x32_bf16 v[100:103], v[68:71], v[44:47], v[100:103]
    v_mfma_f32_16x16x32_bf16 v[104:107], v[72:75], v[44:47], v[104:107]
    v_mfma_f32_16x16x32_bf16 v[108:111], v[76:79], v[44:47], v[108:111]
    v_mfma_f32_16x16x32_bf16 v[112:115], v[80:83], v[44:47], v[112:115]
    v_mfma_f32_16x16x32_bf16 v[116:119], v[84:87], v[44:47], v[116:119]
    s_waitcnt vmcnt(20)
    s_barrier
    s_add_u32 m0, s37, 20480
    s_add_u32 s39, s32, 1664
    s_add_u32 s40, s33, 1664
    buffer_load_dwordx4 v3, s[20:23], s39 offen lds
    buffer_load_dwordx4 v4, s[20:23], s40 offen offset:1024 lds
    s_add_u32 m0, s38, 20480
    s_add_u32 s39, s36, 245760
    buffer_load_dwordx4 v5, s[28:31], s39 offen offset:0 lds
    buffer_load_dwordx4 v6, s[28:31], s39 offen offset:1024 lds
    buffer_load_dwordx4 v7, s[28:31], s39 offen offset:2048 lds
    ds_read_b128 v[40:43], v10 offset:40960
    ds_read_b64_tr_b16 v[48:49], v12 offset:40960
    ds_read_b64_tr_b16 v[50:51], v12 offset:41728
    ds_read_b64_tr_b16 v[52:53], v13 offset:40992
    ds_read_b64_tr_b16 v[54:55], v13 offset:41760
    ds_read_b64_tr_b16 v[56:57], v12 offset:41024
    ds_read_b64_tr_b16 v[58:59], v12 offset:41792
    ds_read_b64_tr_b16 v[60:61], v13 offset:41056
    ds_read_b64_tr_b16 v[62:63], v13 offset:41824
    ds_read_b64_tr_b16 v[64:65], v12 offset:41088
    ds_read_b64_tr_b16 v[66:67], v12 offset:41856
    ds_read_b128 v[44:47], v11 offset:40960
    ds_read_b64_tr_b16 v[68:69], v12 offset:47104
    ds_read_b64_tr_b16 v[70:71], v12 offset:47872
    ds_read_b64_tr_b16 v[72:73], v13 offset:47136
    ds_read_b64_tr_b16 v[74:75], v13 offset:47904
    ds_read_b64_tr_b16 v[76:77], v12 offset:47168
    ds_read_b64_tr_b16 v[78:79], v12 offset:47936
    ds_read_b64_tr_b16 v[80:81], v13 offset:47200
    ds_read_b64_tr_b16 v[82:83], v13 offset:47968
    ds_read_b64_tr_b16 v[84:85], v12 offset:47232
    ds_read_b64_tr_b16 v[86:87], v12 offset:48000
    s_waitcnt lgkmcnt(11)
    v_mfma_f32_16x16x32_bf16 v[100:103], v[48:51], v[40:43], v[100:103]
    v_mfma_f32_16x16x32_bf16 v[104:107], v[52:55], v[40:43], v[104:107]
    v_mfma_f32_16x16x32_bf16 v[108:111], v[56:59], v[40:43], v[108:111]
    v_mfma_f32_16x16x32_bf16 v[112:115], v[60:63], v[40:43], v[112:115]
    v_mfma_f32_16x16x32_bf16 v[116:119], v[64:67], v[40:43], v[116:119]
    s_waitcnt lgkmcnt(0)
    v_mfma_f32_16x16x32_bf16 v[100:103], v[68:71], v[44:47], v[100:103]
    v_mfma_f32_16x16x32_bf16 v[104:107], v[72:75], v[44:47], v[104:107]
    v_mfma_f32_16x16x32_bf16 v[108:111], v[76:79], v[44:47], v[108:111]
    v_mfma_f32_16x16x32_bf16 v[112:115], v[80:83], v[44:47], v[112:115]
    v_mfma_f32_16x16x32_bf16 v[116:119], v[84:87], v[44:47], v[116:119]
    s_waitcnt vmcnt(20)
    s_barrier
    s_add_u32 m0, s37, 40960
    s_add_u32 s39, s32, 1792
    s_add_u32 s40, s33, 1792
    buffer_load_dwordx4 v3, s[20:23], s39 offen lds
    buffer_load_dwordx4 v4, s[20:23], s40 offen offset:1024 lds
    s_add_u32 m0, s38, 40960
    s_add_u32 s39, s36, 327680
    buffer_load_dwordx4 v5, s[28:31], s39 offen offset:0 lds
    buffer_load_dwordx4 v6, s[28:31], s39 offen offset:1024 lds
    buffer_load_dwordx4 v7, s[28:31], s39 offen offset:2048 lds
    ds_read_b128 v[40:43], v30 offset:0
    ds_read_b64_tr_b16 v[48:49], v32 offset:0
    ds_read_b64_tr_b16 v[50:51], v32 offset:768
    ds_read_b64_tr_b16 v[52:53], v33 offset:32
    ds_read_b64_tr_b16 v[54:55], v33 offset:800
    ds_read_b64_tr_b16 v[56:57], v32 offset:64
    ds_read_b64_tr_b16 v[58:59], v32 offset:832
    ds_read_b64_tr_b16 v[60:61], v33 offset:96
    ds_read_b64_tr_b16 v[62:63], v33 offset:864
    ds_read_b64_tr_b16 v[64:65], v32 offset:128
    ds_read_b64_tr_b16 v[66:67], v32 offset:896
    ds_read_b128 v[44:47], v31 offset:0
    ds_read_b64_tr_b16 v[68:69], v32 offset:6144
    ds_read_b64_tr_b16 v[70:71], v32 offset:6912
    ds_read_b64_tr_b16 v[72:73], v33 offset:6176
    ds_read_b64_tr_b16 v[74:75], v33 offset:6944
    ds_read_b64_tr_b16 v[76:77], v32 offset:6208
    ds_read_b64_tr_b16 v[78:79], v32 offset:6976
    ds_read_b64_tr_b16 v[80:81], v33 offset:6240
    ds_read_b64_tr_b16 v[82:83], v33 offset:7008
    ds_read_b64_tr_b16 v[84:85], v32 offset:6272
    ds_read_b64_tr_b16 v[86:87], v32 offset:7040
    s_waitcnt lgkmcnt(11)
    v_mfma_f32_16x16x32_bf16 v[100:103], v[48:51], v[40:43], v[100:103]
    v_mfma_f32_16x16x32_bf16 v[104:107], v[52:55], v[40:43], v[104:107]
    v_mfma_f32_16x16x32_bf16 v[108:111], v[56:59], v[40:43], v[108:111]
    v_mfma_f32_16x16x32_bf16 v[112:115], v[60:63], v[40:43], v[112:115]
    v_mfma_f32_16x16x32_bf16 v[116:119], v[64:67], v[40:43], v[116:119]
    s_waitcnt lgkmcnt(0)
    v_mfma_f32_16x16x32_bf16 v[100:103], v[68:71], v[44:47], v[100:103]
    v_mfma_f32_16x16x32_bf16 v[104:107], v[72:75], v[44:47], v[104:107]
    v_mfma_f32_16x16x32_bf16 v[108:111], v[76:79], v[44:47], v[108:111]
    v_mfma_f32_16x16x32_bf16 v[112:115], v[80:83], v[44:47], v[112:115]
    v_mfma_f32_16x16x32_bf16 v[116:119], v[84:87], v[44:47], v[116:119]
    s_waitcnt vmcnt(20)
    s_barrier
    s_add_u32 m0, s37, 61440
    s_add_u32 s39, s32, 1920
    s_add_u32 s40, s33, 1920
    buffer_load_dwordx4 v3, s[20:23], s39 offen lds
    buffer_load_dwordx4 v4, s[20:23], s40 offen offset:1024 lds
    s_add_u32 m0, s38, 61440
    s_add_u32 s39, s36, 409600
    buffer_load_dwordx4 v5, s[28:31], s39 offen offset:0 lds
    buffer_load_dwordx4 v6, s[28:31], s39 offen offset:1024 lds
    buffer_load_dwordx4 v7, s[28:31], s39 offen offset:2048 lds
    ds_read_b128 v[40:43], v30 offset:20480
    ds_read_b64_tr_b16 v[48:49], v32 offset:20480
    ds_read_b64_tr_b16 v[50:51], v32 offset:21248
    ds_read_b64_tr_b16 v[52:53], v33 offset:20512
    ds_read_b64_tr_b16 v[54:55], v33 offset:21280
    ds_read_b64_tr_b16 v[56:57], v32 offset:20544
    ds_read_b64_tr_b16 v[58:59], v32 offset:21312
    ds_read_b64_tr_b16 v[60:61], v33 offset:20576
    ds_read_b64_tr_b16 v[62:63], v33 offset:21344
    ds_read_b64_tr_b16 v[64:65], v32 offset:20608
    ds_read_b64_tr_b16 v[66:67], v32 offset:21376
    ds_read_b128 v[44:47], v31 offset:20480
    ds_read_b64_tr_b16 v[68:69], v32 offset:26624
    ds_read_b64_tr_b16 v[70:71], v32 offset:27392
    ds_read_b64_tr_b16 v[72:73], v33 offset:26656
    ds_read_b64_tr_b16 v[74:75], v33 offset:27424
    ds_read_b64_tr_b16 v[76:77], v32 offset:26688
    ds_read_b64_tr_b16 v[78:79], v32 offset:27456
    ds_read_b64_tr_b16 v[80:81], v33 offset:26720
    ds_read_b64_tr_b16 v[82:83], v33 offset:27488
    ds_read_b64_tr_b16 v[84:85], v32 offset:26752
    ds_read_b64_tr_b16 v[86:87], v32 offset:27520
    s_waitcnt lgkmcnt(11)
    v_mfma_f32_16x16x32_bf16 v[100:103], v[48:51], v[40:43], v[100:103]
    v_mfma_f32_16x16x32_bf16 v[104:107], v[52:55], v[40:43], v[104:107]
    v_mfma_f32_16x16x32_bf16 v[108:111], v[56:59], v[40:43], v[108:111]
    v_mfma_f32_16x16x32_bf16 v[112:115], v[60:63], v[40:43], v[112:115]
    v_mfma_f32_16x16x32_bf16 v[116:119], v[64:67], v[40:43], v[116:119]
    s_waitcnt lgkmcnt(0)
    v_mfma_f32_16x16x32_bf16 v[100:103], v[68:71], v[44:47], v[100:103]
    v_mfma_f32_16x16x32_bf16 v[104:107], v[72:75], v[44:47], v[104:107]
    v_mfma_f32_16x16x32_bf16 v[108:111], v[76:79], v[44:47], v[108:111]
    v_mfma_f32_16x16x32_bf16 v[112:115], v[80:83], v[44:47], v[112:115]
    v_mfma_f32_16x16x32_bf16 v[116:119], v[84:87], v[44:47], v[116:119]
    s_waitcnt vmcnt(20)
    s_barrier
    s_add_u32 m0, s37, 81920
    s_add_u32 s39, s32, 2048
    s_add_u32 s40, s33, 2048
    buffer_load_dwordx4 v3, s[20:23], s39 offen lds
    buffer_load_dwordx4 v4, s[20:23], s40 offen offset:1024 lds
    s_add_u32 m0, s38, 81920
    s_add_u32 s39, s36, 491520
    buffer_load_dwordx4 v5, s[28:31], s39 offen offset:0 lds
    buffer_load_dwordx4 v6, s[28:31], s39 offen offset:1024 lds
    buffer_load_dwordx4 v7, s[28:31], s39 offen offset:2048 lds
    ds_read_b128 v[40:43], v30 offset:40960
    ds_read_b64_tr_b16 v[48:49], v32 offset:40960
    ds_read_b64_tr_b16 v[50:51], v32 offset:41728
    ds_read_b64_tr_b16 v[52:53], v33 offset:40992
    ds_read_b64_tr_b16 v[54:55], v33 offset:41760
    ds_read_b64_tr_b16 v[56:57], v32 offset:41024
    ds_read_b64_tr_b16 v[58:59], v32 offset:41792
    ds_read_b64_tr_b16 v[60:61], v33 offset:41056
    ds_read_b64_tr_b16 v[62:63], v33 offset:41824
    ds_read_b64_tr_b16 v[64:65], v32 offset:41088
    ds_read_b64_tr_b16 v[66:67], v32 offset:41856
    ds_read_b128 v[44:47], v31 offset:40960
    ds_read_b64_tr_b16 v[68:69], v32 offset:47104
    ds_read_b64_tr_b16 v[70:71], v32 offset:47872
    ds_read_b64_tr_b16 v[72:73], v33 offset:47136
    ds_read_b64_tr_b16 v[74:75], v33 offset:47904
    ds_read_b64_tr_b16 v[76:77], v32 offset:47168
    ds_read_b64_tr_b16 v[78:79], v32 offset:47936
    ds_read_b64_tr_b16 v[80:81], v33 offset:47200
    ds_read_b64_tr_b16 v[82:83], v33 offset:47968
    ds_read_b64_tr_b16 v[84:85], v32 offset:47232
    ds_read_b64_tr_b16 v[86:87], v32 offset:48000
    s_waitcnt lgkmcnt(11)
    v_mfma_f32_16x16x32_bf16 v[100:103], v[48:51], v[40:43], v[100:103]
    v_mfma_f32_16x16x32_bf16 v[104:107], v[52:55], v[40:43], v[104:107]
    v_mfma_f32_16x16x32_bf16 v[108:111], v[56:59], v[40:43], v[108:111]
    v_mfma_f32_16x16x32_bf16 v[112:115], v[60:63], v[40:43], v[112:115]
    v_mfma_f32_16x16x32_bf16 v[116:119], v[64:67], v[40:43], v[116:119]
    s_waitcnt lgkmcnt(0)
    v_mfma_f32_16x16x32_bf16 v[100:103], v[68:71], v[44:47], v[100:103]
    v_mfma_f32_16x16x32_bf16 v[104:107], v[72:75], v[44:47], v[104:107]
    v_mfma_f32_16x16x32_bf16 v[108:111], v[76:79], v[44:47], v[108:111]
    v_mfma_f32_16x16x32_bf16 v[112:115], v[80:83], v[44:47], v[112:115]
    v_mfma_f32_16x16x32_bf16 v[116:119], v[84:87], v[44:47], v[116:119]
    s_waitcnt vmcnt(20)
    s_barrier
    s_add_u32 m0, s37, 102400
    s_add_u32 s39, s32, 2176
    s_add_u32 s40, s33, 2176
    buffer_load_dwordx4 v3, s[20:23], s39 offen lds
    buffer_load_dwordx4 v4, s[20:23], s40 offen offset:1024 lds
    s_add_u32 m0, s38, 102400
    s_add_u32 s39, s36, 573440
    buffer_load_dwordx4 v5, s[28:31], s39 offen offset:0 lds
    buffer_load_dwordx4 v6, s[28:31], s39 offen offset:1024 lds
    buffer_load_dwordx4 v7, s[28:31], s39 offen offset:2048 lds
    ds_read_b128 v[40:43], v10 offset:0
    ds_read_b64_tr_b16 v[48:49], v12 offset:0
    ds_read_b64_tr_b16 v[50:51], v12 offset:768
    ds_read_b64_tr_b16 v[52:53], v13 offset:32
    ds_read_b64_tr_b16 v[54:55], v13 offset:800
    ds_read_b64_tr_b16 v[56:57], v12 offset:64
    ds_read_b64_tr_b16 v[58:59], v12 offset:832
    ds_read_b64_tr_b16 v[60:61], v13 offset:96
    ds_read_b64_tr_b16 v[62:63], v13 offset:864
    ds_read_b64_tr_b16 v[64:65], v12 offset:128
    ds_read_b64_tr_b16 v[66:67], v12 offset:896
    ds_read_b128 v[44:47], v11 offset:0
    ds_read_b64_tr_b16 v[68:69], v12 offset:6144
    ds_read_b64_tr_b16 v[70:71], v12 offset:6912
    ds_read_b64_tr_b16 v[72:73], v13 offset:6176
    ds_read_b64_tr_b16 v[74:75], v13 offset:6944
    ds_read_b64_tr_b16 v[76:77], v12 offset:6208
    ds_read_b64_tr_b16 v[78:79], v12 offset:6976
    ds_read_b64_tr_b16 v[80:81], v13 offset:6240
    ds_read_b64_tr_b16 v[82:83], v13 offset:7008
    ds_read_b64_tr_b16 v[84:85], v12 offset:6272
    ds_read_b64_tr_b16 v[86:87], v12 offset:7040
    s_waitcnt lgkmcnt(11)
    v_mfma_f32_16x16x32_bf16 v[100:103], v[48:51], v[40:43], v[100:103]
    v_mfma_f32_16x16x32_bf16 v[104:107], v[52:55], v[40:43], v[104:107]
    v_mfma_f32_16x16x32_bf16 v[108:111], v[56:59], v[40:43], v[108:111]
    v_mfma_f32_16x16x32_bf16 v[112:115], v[60:63], v[40:43], v[112:115]
    v_mfma_f32_16x16x32_bf16 v[116:119], v[64:67], v[40:43], v[116:119]
    s_waitcnt lgkmcnt(0)
    v_mfma_f32_16x16x32_bf16 v[100:103], v[68:71], v[44:47], v[100:103]
    v_mfma_f32_16x16x32_bf16 v[104:107], v[72:75], v[44:47], v[104:107]
    v_mfma_f32_16x16x32_bf16 v[108:111], v[76:79], v[44:47], v[108:111]
    v_mfma_f32_16x16x32_bf16 v[112:115], v[80:83], v[44:47], v[112:115]
    v_mfma_f32_16x16x32_bf16 v[116:119], v[84:87], v[44:47], v[116:119]
    s_waitcnt vmcnt(20)
    s_barrier
    s_add_u32 m0, s37, 0
    s_add_u32 s39, s32, 2304
    s_add_u32 s40, s33, 2304
    buffer_load_dwordx4 v3, s[20:23], s39 offen lds
    buffer_load_dwordx4 v4, s[20:23], s40 offen offset:1024 lds
    s_add_u32 m0, s38, 0
    s_add_u32 s39, s36, 655360
    buffer_load_dwordx4 v5, s[28:31], s39 offen offset:0 lds
    buffer_load_dwordx4 v6, s[28:31], s39 offen offset:1024 lds
    buffer_load_dwordx4 v7, s[28:31], s39 offen offset:2048 lds
    ds_read_b128 v[40:43], v10 offset:20480
    ds_read_b64_tr_b16 v[48:49], v12 offset:20480
    ds_read_b64_tr_b16 v[50:51], v12 offset:21248
    ds_read_b64_tr_b16 v[52:53], v13 offset:20512
    ds_read_b64_tr_b16 v[54:55], v13 offset:21280
    ds_read_b64_tr_b16 v[56:57], v12 offset:20544
    ds_read_b64_tr_b16 v[58:59], v12 offset:21312
    ds_read_b64_tr_b16 v[60:61], v13 offset:20576
    ds_read_b64_tr_b16 v[62:63], v13 offset:21344
    ds_read_b64_tr_b16 v[64:65], v12 offset:20608
    ds_read_b64_tr_b16 v[66:67], v12 offset:21376
    ds_read_b128 v[44:47], v11 offset:20480
    ds_read_b64_tr_b16 v[68:69], v12 offset:26624
    ds_read_b64_tr_b16 v[70:71], v12 offset:27392
    ds_read_b64_tr_b16 v[72:73], v13 offset:26656
    ds_read_b64_tr_b16 v[74:75], v13 offset:27424
    ds_read_b64_tr_b16 v[76:77], v12 offset:26688
    ds_read_b64_tr_b16 v[78:79], v12 offset:27456
    ds_read_b64_tr_b16 v[80:81], v13 offset:26720
    ds_read_b64_tr_b16 v[82:83], v13 offset:27488
    ds_read_b64_tr_b16 v[84:85], v12 offset:26752
    ds_read_b64_tr_b16 v[86:87], v12 offset:27520
    s_waitcnt lgkmcnt(11)
    v_mfma_f32_16x16x32_bf16 v[100:103], v[48:51], v[40:43], v[100:103]
    v_mfma_f32_16x16x32_bf16 v[104:107], v[52:55], v[40:43], v[104:107]
    v_mfma_f32_16x16x32_bf16 v[108:111], v[56:59], v[40:43], v[108:111]
    v_mfma_f32_16x16x32_bf16 v[112:115], v[60:63], v[40:43], v[112:115]
    v_mfma_f32_16x16x32_bf16 v[116:119], v[64:67], v[40:43], v[116:119]
    s_waitcnt lgkmcnt(0)
    v_mfma_f32_16x16x32_bf16 v[100:103], v[68:71], v[44:47], v[100:103]
    v_mfma_f32_16x16x32_bf16 v[104:107], v[72:75], v[44:47], v[104:107]
    v_mfma_f32_16x16x32_bf16 v[108:111], v[76:79], v[44:47], v[108:111]
    v_mfma_f32_16x16x32_bf16 v[112:115], v[80:83], v[44:47], v[112:115]
    v_mfma_f32_16x16x32_bf16 v[116:119], v[84:87], v[44:47], v[116:119]
    s_waitcnt vmcnt(20)
    s_barrier
    s_add_u32 m0, s37, 20480
    s_add_u32 s39, s32, 2432
    s_add_u32 s40, s33, 2432
    buffer_load_dwordx4 v3, s[20:23], s39 offen lds
    buffer_load_dwordx4 v4, s[20:23], s40 offen offset:1024 lds
    s_add_u32 m0, s38, 20480
    s_add_u32 s39, s36, 737280
    buffer_load_dwordx4 v5, s[28:31], s39 offen offset:0 lds
    buffer_load_dwordx4 v6, s[28:31], s39 offen offset:1024 lds
    buffer_load_dwordx4 v7, s[28:31], s39 offen offset:2048 lds
    ds_read_b128 v[40:43], v10 offset:40960
    ds_read_b64_tr_b16 v[48:49], v12 offset:40960
    ds_read_b64_tr_b16 v[50:51], v12 offset:41728
    ds_read_b64_tr_b16 v[52:53], v13 offset:40992
    ds_read_b64_tr_b16 v[54:55], v13 offset:41760
    ds_read_b64_tr_b16 v[56:57], v12 offset:41024
    ds_read_b64_tr_b16 v[58:59], v12 offset:41792
    ds_read_b64_tr_b16 v[60:61], v13 offset:41056
    ds_read_b64_tr_b16 v[62:63], v13 offset:41824
    ds_read_b64_tr_b16 v[64:65], v12 offset:41088
    ds_read_b64_tr_b16 v[66:67], v12 offset:41856
    ds_read_b128 v[44:47], v11 offset:40960
    ds_read_b64_tr_b16 v[68:69], v12 offset:47104
    ds_read_b64_tr_b16 v[70:71], v12 offset:47872
    ds_read_b64_tr_b16 v[72:73], v13 offset:47136
    ds_read_b64_tr_b16 v[74:75], v13 offset:47904
    ds_read_b64_tr_b16 v[76:77], v12 offset:47168
    ds_read_b64_tr_b16 v[78:79], v12 offset:47936
    ds_read_b64_tr_b16 v[80:81], v13 offset:47200
    ds_read_b64_tr_b16 v[82:83], v13 offset:47968
    ds_read_b64_tr_b16 v[84:85], v12 offset:47232
    ds_read_b64_tr_b16 v[86:87], v12 offset:48000
    s_waitcnt lgkmcnt(11)
    v_mfma_f32_16x16x32_bf16 v[100:103], v[48:51], v[40:43], v[100:103]
    v_mfma_f32_16x16x32_bf16 v[104:107], v[52:55], v[40:43], v[104:107]
    v_mfma_f32_16x16x32_bf16 v[108:111], v[56:59], v[40:43], v[108:111]
    v_mfma_f32_16x16x32_bf16 v[112:115], v[60:63], v[40:43], v[112:115]
    v_mfma_f32_16x16x32_bf16 v[116:119], v[64:67], v[40:43], v[116:119]
    s_waitcnt lgkmcnt(0)
    v_mfma_f32_16x16x32_bf16 v[100:103], v[68:71], v[44:47], v[100:103]
    v_mfma_f32_16x16x32_bf16 v[104:107], v[72:75], v[44:47], v[104:107]
    v_mfma_f32_16x16x32_bf16 v[108:111], v[76:79], v[44:47], v[108:111]
    v_mfma_f32_16x16x32_bf16 v[112:115], v[80:83], v[44:47], v[112:115]
    v_mfma_f32_16x16x32_bf16 v[116:119], v[84:87], v[44:47], v[116:119]
    s_waitcnt vmcnt(20)
    s_barrier
    s_add_u32 m0, s37, 40960
    s_add_u32 s39, s32, 2560
    s_add_u32 s40, s33, 2560
    buffer_load_dwordx4 v3, s[20:23], s39 offen lds
    buffer_load_dwordx4 v4, s[20:23], s40 offen offset:1024 lds
    s_add_u32 m0, s38, 40960
    s_add_u32 s39, s36, 819200
    buffer_load_dwordx4 v5, s[28:31], s39 offen offset:0 lds
    buffer_load_dwordx4 v6, s[28:31], s39 offen offset:1024 lds
    buffer_load_dwordx4 v7, s[28:31], s39 offen offset:2048 lds
    ds_read_b128 v[40:43], v30 offset:0
    ds_read_b64_tr_b16 v[48:49], v32 offset:0
    ds_read_b64_tr_b16 v[50:51], v32 offset:768
    ds_read_b64_tr_b16 v[52:53], v33 offset:32
    ds_read_b64_tr_b16 v[54:55], v33 offset:800
    ds_read_b64_tr_b16 v[56:57], v32 offset:64
    ds_read_b64_tr_b16 v[58:59], v32 offset:832
    ds_read_b64_tr_b16 v[60:61], v33 offset:96
    ds_read_b64_tr_b16 v[62:63], v33 offset:864
    ds_read_b64_tr_b16 v[64:65], v32 offset:128
    ds_read_b64_tr_b16 v[66:67], v32 offset:896
    ds_read_b128 v[44:47], v31 offset:0
    ds_read_b64_tr_b16 v[68:69], v32 offset:6144
    ds_read_b64_tr_b16 v[70:71], v32 offset:6912
    ds_read_b64_tr_b16 v[72:73], v33 offset:6176
    ds_read_b64_tr_b16 v[74:75], v33 offset:6944
    ds_read_b64_tr_b16 v[76:77], v32 offset:6208
    ds_read_b64_tr_b16 v[78:79], v32 offset:6976
    ds_read_b64_tr_b16 v[80:81], v33 offset:6240
    ds_read_b64_tr_b16 v[82:83], v33 offset:7008
    ds_read_b64_tr_b16 v[84:85], v32 offset:6272
    ds_read_b64_tr_b16 v[86:87], v32 offset:7040
    s_waitcnt lgkmcnt(11)
    v_mfma_f32_16x16x32_bf16 v[100:103], v[48:51], v[40:43], v[100:103]
    v_mfma_f32_16x16x32_bf16 v[104:107], v[52:55], v[40:43], v[104:107]
    v_mfma_f32_16x16x32_bf16 v[108:111], v[56:59], v[40:43], v[108:111]
    v_mfma_f32_16x16x32_bf16 v[112:115], v[60:63], v[40:43], v[112:115]
    v_mfma_f32_16x16x32_bf16 v[116:119], v[64:67], v[40:43], v[116:119]
    s_waitcnt lgkmcnt(0)
    v_mfma_f32_16x16x32_bf16 v[100:103], v[68:71], v[44:47], v[100:103]
    v_mfma_f32_16x16x32_bf16 v[104:107], v[72:75], v[44:47], v[104:107]
    v_mfma_f32_16x16x32_bf16 v[108:111], v[76:79], v[44:47], v[108:111]
    v_mfma_f32_16x16x32_bf16 v[112:115], v[80:83], v[44:47], v[112:115]
    v_mfma_f32_16x16x32_bf16 v[116:119], v[84:87], v[44:47], v[116:119]
    s_waitcnt vmcnt(20)
    s_barrier
    s_add_u32 m0, s37, 61440
    s_add_u32 s39, s32, 2688
    s_add_u32 s40, s33, 2688
    buffer_load_dwordx4 v3, s[20:23], s39 offen lds
    buffer_load_dwordx4 v4, s[20:23], s40 offen offset:1024 lds
    s_add_u32 m0, s38, 61440
    s_add_u32 s39, s36, 901120
    buffer_load_dwordx4 v5, s[28:31], s39 offen offset:0 lds
    buffer_load_dwordx4 v6, s[28:31], s39 offen offset:1024 lds
    buffer_load_dwordx4 v7, s[28:31], s39 offen offset:2048 lds
    ds_read_b128 v[40:43], v30 offset:20480
    ds_read_b64_tr_b16 v[48:49], v32 offset:20480
    ds_read_b64_tr_b16 v[50:51], v32 offset:21248
    ds_read_b64_tr_b16 v[52:53], v33 offset:20512
    ds_read_b64_tr_b16 v[54:55], v33 offset:21280
    ds_read_b64_tr_b16 v[56:57], v32 offset:20544
    ds_read_b64_tr_b16 v[58:59], v32 offset:21312
    ds_read_b64_tr_b16 v[60:61], v33 offset:20576
    ds_read_b64_tr_b16 v[62:63], v33 offset:21344
    ds_read_b64_tr_b16 v[64:65], v32 offset:20608
    ds_read_b64_tr_b16 v[66:67], v32 offset:21376
    ds_read_b128 v[44:47], v31 offset:20480
    ds_read_b64_tr_b16 v[68:69], v32 offset:26624
    ds_read_b64_tr_b16 v[70:71], v32 offset:27392
    ds_read_b64_tr_b16 v[72:73], v33 offset:26656
    ds_read_b64_tr_b16 v[74:75], v33 offset:27424
    ds_read_b64_tr_b16 v[76:77], v32 offset:26688
    ds_read_b64_tr_b16 v[78:79], v32 offset:27456
    ds_read_b64_tr_b16 v[80:81], v33 offset:26720
    ds_read_b64_tr_b16 v[82:83], v33 offset:27488
    ds_read_b64_tr_b16 v[84:85], v32 offset:26752
    ds_read_b64_tr_b16 v[86:87], v32 offset:27520
    s_waitcnt lgkmcnt(11)
    v_mfma_f32_16x16x32_bf16 v[100:103], v[48:51], v[40:43], v[100:103]
    v_mfma_f32_16x16x32_bf16 v[104:107], v[52:55], v[40:43], v[104:107]
    v_mfma_f32_16x16x32_bf16 v[108:111], v[56:59], v[40:43], v[108:111]
    v_mfma_f32_16x16x32_bf16 v[112:115], v[60:63], v[40:43], v[112:115]
    v_mfma_f32_16x16x32_bf16 v[116:119], v[64:67], v[40:43], v[116:119]
    s_waitcnt lgkmcnt(0)
    v_mfma_f32_16x16x32_bf16 v[100:103], v[68:71], v[44:47], v[100:103]
    v_mfma_f32_16x16x32_bf16 v[104:107], v[72:75], v[44:47], v[104:107]
    v_mfma_f32_16x16x32_bf16 v[108:111], v[76:79], v[44:47], v[108:111]
    v_mfma_f32_16x16x32_bf16 v[112:115], v[80:83], v[44:47], v[112:115]
    v_mfma_f32_16x16x32_bf16 v[116:119], v[84:87], v[44:47], v[116:119]
    s_waitcnt vmcnt(20)
    s_barrier
    s_add_u32 m0, s37, 81920
    s_add_u32 s39, s32, 2816
    s_add_u32 s40, s33, 2816
    buffer_load_dwordx4 v3, s[20:23], s39 offen lds
    buffer_load_dwordx4 v4, s[20:23], s40 offen offset:1024 lds
    s_add_u32 m0, s38, 81920
    s_add_u32 s39, s36, 983040
    buffer_load_dwordx4 v5, s[28:31], s39 offen offset:0 lds
    buffer_load_dwordx4 v6, s[28:31], s39 offen offset:1024 lds
    buffer_load_dwordx4 v7, s[28:31], s39 offen offset:2048 lds
    ds_read_b128 v[40:43], v30 offset:40960
    ds_read_b64_tr_b16 v[48:49], v32 offset:40960
    ds_read_b64_tr_b16 v[50:51], v32 offset:41728
    ds_read_b64_tr_b16 v[52:53], v33 offset:40992
    ds_read_b64_tr_b16 v[54:55], v33 offset:41760
    ds_read_b64_tr_b16 v[56:57], v32 offset:41024
    ds_read_b64_tr_b16 v[58:59], v32 offset:41792
    ds_read_b64_tr_b16 v[60:61], v33 offset:41056
    ds_read_b64_tr_b16 v[62:63], v33 offset:41824
    ds_read_b64_tr_b16 v[64:65], v32 offset:41088
    ds_read_b64_tr_b16 v[66:67], v32 offset:41856
    ds_read_b128 v[44:47], v31 offset:40960
    ds_read_b64_tr_b16 v[68:69], v32 offset:47104
    ds_read_b64_tr_b16 v[70:71], v32 offset:47872
    ds_read_b64_tr_b16 v[72:73], v33 offset:47136
    ds_read_b64_tr_b16 v[74:75], v33 offset:47904
    ds_read_b64_tr_b16 v[76:77], v32 offset:47168
    ds_read_b64_tr_b16 v[78:79], v32 offset:47936
    ds_read_b64_tr_b16 v[80:81], v33 offset:47200
    ds_read_b64_tr_b16 v[82:83], v33 offset:47968
    ds_read_b64_tr_b16 v[84:85], v32 offset:47232
    ds_read_b64_tr_b16 v[86:87], v32 offset:48000
    s_waitcnt lgkmcnt(11)
    v_mfma_f32_16x16x32_bf16 v[100:103], v[48:51], v[40:43], v[100:103]
    v_mfma_f32_16x16x32_bf16 v[104:107], v[52:55], v[40:43], v[104:107]
    v_mfma_f32_16x16x32_bf16 v[108:111], v[56:59], v[40:43], v[108:111]
    v_mfma_f32_16x16x32_bf16 v[112:115], v[60:63], v[40:43], v[112:115]
    v_mfma_f32_16x16x32_bf16 v[116:119], v[64:67], v[40:43], v[116:119]
    s_waitcnt lgkmcnt(0)
    v_mfma_f32_16x16x32_bf16 v[100:103], v[68:71], v[44:47], v[100:103]
    v_mfma_f32_16x16x32_bf16 v[104:107], v[72:75], v[44:47], v[104:107]
    v_mfma_f32_16x16x32_bf16 v[108:111], v[76:79], v[44:47], v[108:111]
    v_mfma_f32_16x16x32_bf16 v[112:115], v[80:83], v[44:47], v[112:115]
    v_mfma_f32_16x16x32_bf16 v[116:119], v[84:87], v[44:47], v[116:119]
    s_waitcnt vmcnt(20)
    s_barrier
    s_add_u32 m0, s37, 102400
    s_add_u32 s39, s32, 2944
    s_add_u32 s40, s33, 2944
    buffer_load_dwordx4 v3, s[20:23], s39 offen lds
    buffer_load_dwordx4 v4, s[20:23], s40 offen offset:1024 lds
    s_add_u32 m0, s38, 102400
    s_add_u32 s39, s36, 1064960
    buffer_load_dwordx4 v5, s[28:31], s39 offen offset:0 lds
    buffer_load_dwordx4 v6, s[28:31], s39 offen offset:1024 lds
    buffer_load_dwordx4 v7, s[28:31], s39 offen offset:2048 lds
    ds_read_b128 v[40:43], v10 offset:0
    ds_read_b64_tr_b16 v[48:49], v12 offset:0
    ds_read_b64_tr_b16 v[50:51], v12 offset:768
    ds_read_b64_tr_b16 v[52:53], v13 offset:32
    ds_read_b64_tr_b16 v[54:55], v13 offset:800
    ds_read_b64_tr_b16 v[56:57], v12 offset:64
    ds_read_b64_tr_b16 v[58:59], v12 offset:832
    ds_read_b64_tr_b16 v[60:61], v13 offset:96
    ds_read_b64_tr_b16 v[62:63], v13 offset:864
    ds_read_b64_tr_b16 v[64:65], v12 offset:128
    ds_read_b64_tr_b16 v[66:67], v12 offset:896
    ds_read_b128 v[44:47], v11 offset:0
    ds_read_b64_tr_b16 v[68:69], v12 offset:6144
    ds_read_b64_tr_b16 v[70:71], v12 offset:6912
    ds_read_b64_tr_b16 v[72:73], v13 offset:6176
    ds_read_b64_tr_b16 v[74:75], v13 offset:6944
    ds_read_b64_tr_b16 v[76:77], v12 offset:6208
    ds_read_b64_tr_b16 v[78:79], v12 offset:6976
    ds_read_b64_tr_b16 v[80:81], v13 offset:6240
    ds_read_b64_tr_b16 v[82:83], v13 offset:7008
    ds_read_b64_tr_b16 v[84:85], v12 offset:6272
    ds_read_b64_tr_b16 v[86:87], v12 offset:7040
    s_waitcnt lgkmcnt(11)
    v_mfma_f32_16x16x32_bf16 v[100:103], v[48:51], v[40:43], v[100:103]
    v_mfma_f32_16x16x32_bf16 v[104:107], v[52:55], v[40:43], v[104:107]
    v_mfma_f32_16x16x32_bf16 v[108:111], v[56:59], v[40:43], v[108:111]
    v_mfma_f32_16x16x32_bf16 v[112:115], v[60:63], v[40:43], v[112:115]
    v_mfma_f32_16x16x32_bf16 v[116:119], v[64:67], v[40:43], v[116:119]
    s_waitcnt lgkmcnt(0)
    v_mfma_f32_16x16x32_bf16 v[100:103], v[68:71], v[44:47], v[100:103]
    v_mfma_f32_16x16x32_bf16 v[104:107], v[72:75], v[44:47], v[104:107]
    v_mfma_f32_16x16x32_bf16 v[108:111], v[76:79], v[44:47], v[108:111]
    v_mfma_f32_16x16x32_bf16 v[112:115], v[80:83], v[44:47], v[112:115]
    v_mfma_f32_16x16x32_bf16 v[116:119], v[84:87], v[44:47], v[116:119]
    s_waitcnt vmcnt(20)
    s_barrier
    s_add_u32 m0, s37, 0
    s_add_u32 s39, s32, 3072
    s_add_u32 s40, s33, 3072
    buffer_load_dwordx4 v3, s[20:23], s39 offen lds
    buffer_load_dwordx4 v4, s[20:23], s40 offen offset:1024 lds
    s_add_u32 m0, s38, 0
    s_add_u32 s39, s36, 1146880
    buffer_load_dwordx4 v5, s[28:31], s39 offen offset:0 lds
    buffer_load_dwordx4 v6, s[28:31], s39 offen offset:1024 lds
    buffer_load_dwordx4 v7, s[28:31], s39 offen offset:2048 lds
    ds_read_b128 v[40:43], v10 offset:20480
    ds_read_b64_tr_b16 v[48:49], v12 offset:20480
    ds_read_b64_tr_b16 v[50:51], v12 offset:21248
    ds_read_b64_tr_b16 v[52:53], v13 offset:20512
    ds_read_b64_tr_b16 v[54:55], v13 offset:21280
    ds_read_b64_tr_b16 v[56:57], v12 offset:20544
    ds_read_b64_tr_b16 v[58:59], v12 offset:21312
    ds_read_b64_tr_b16 v[60:61], v13 offset:20576
    ds_read_b64_tr_b16 v[62:63], v13 offset:21344
    ds_read_b64_tr_b16 v[64:65], v12 offset:20608
    ds_read_b64_tr_b16 v[66:67], v12 offset:21376
    ds_read_b128 v[44:47], v11 offset:20480
    ds_read_b64_tr_b16 v[68:69], v12 offset:26624
    ds_read_b64_tr_b16 v[70:71], v12 offset:27392
    ds_read_b64_tr_b16 v[72:73], v13 offset:26656
    ds_read_b64_tr_b16 v[74:75], v13 offset:27424
    ds_read_b64_tr_b16 v[76:77], v12 offset:26688
    ds_read_b64_tr_b16 v[78:79], v12 offset:27456
    ds_read_b64_tr_b16 v[80:81], v13 offset:26720
    ds_read_b64_tr_b16 v[82:83], v13 offset:27488
    ds_read_b64_tr_b16 v[84:85], v12 offset:26752
    ds_read_b64_tr_b16 v[86:87], v12 offset:27520
    s_waitcnt lgkmcnt(11)
    v_mfma_f32_16x16x32_bf16 v[100:103], v[48:51], v[40:43], v[100:103]
    v_mfma_f32_16x16x32_bf16 v[104:107], v[52:55], v[40:43], v[104:107]
    v_mfma_f32_16x16x32_bf16 v[108:111], v[56:59], v[40:43], v[108:111]
    v_mfma_f32_16x16x32_bf16 v[112:115], v[60:63], v[40:43], v[112:115]
    v_mfma_f32_16x16x32_bf16 v[116:119], v[64:67], v[40:43], v[116:119]
    s_waitcnt lgkmcnt(0)
    v_mfma_f32_16x16x32_bf16 v[100:103], v[68:71], v[44:47], v[100:103]
    v_mfma_f32_16x16x32_bf16 v[104:107], v[72:75], v[44:47], v[104:107]
    v_mfma_f32_16x16x32_bf16 v[108:111], v[76:79], v[44:47], v[108:111]
    v_mfma_f32_16x16x32_bf16 v[112:115], v[80:83], v[44:47], v[112:115]
    v_mfma_f32_16x16x32_bf16 v[116:119], v[84:87], v[44:47], v[116:119]
    s_waitcnt vmcnt(20)
    s_barrier
    s_add_u32 m0, s37, 20480
    s_add_u32 s39, s32, 3200
    s_add_u32 s40, s33, 3200
    buffer_load_dwordx4 v3, s[20:23], s39 offen lds
    buffer_load_dwordx4 v4, s[20:23], s40 offen offset:1024 lds
    s_add_u32 m0, s38, 20480
    s_add_u32 s39, s36, 1228800
    buffer_load_dwordx4 v5, s[28:31], s39 offen offset:0 lds
    buffer_load_dwordx4 v6, s[28:31], s39 offen offset:1024 lds
    buffer_load_dwordx4 v7, s[28:31], s39 offen offset:2048 lds
    ds_read_b128 v[40:43], v10 offset:40960
    ds_read_b64_tr_b16 v[48:49], v12 offset:40960
    ds_read_b64_tr_b16 v[50:51], v12 offset:41728
    ds_read_b64_tr_b16 v[52:53], v13 offset:40992
    ds_read_b64_tr_b16 v[54:55], v13 offset:41760
    ds_read_b64_tr_b16 v[56:57], v12 offset:41024
    ds_read_b64_tr_b16 v[58:59], v12 offset:41792
    ds_read_b64_tr_b16 v[60:61], v13 offset:41056
    ds_read_b64_tr_b16 v[62:63], v13 offset:41824
    ds_read_b64_tr_b16 v[64:65], v12 offset:41088
    ds_read_b64_tr_b16 v[66:67], v12 offset:41856
    ds_read_b128 v[44:47], v11 offset:40960
    ds_read_b64_tr_b16 v[68:69], v12 offset:47104
    ds_read_b64_tr_b16 v[70:71], v12 offset:47872
    ds_read_b64_tr_b16 v[72:73], v13 offset:47136
    ds_read_b64_tr_b16 v[74:75], v13 offset:47904
    ds_read_b64_tr_b16 v[76:77], v12 offset:47168
    ds_read_b64_tr_b16 v[78:79], v12 offset:47936
    ds_read_b64_tr_b16 v[80:81], v13 offset:47200
    ds_read_b64_tr_b16 v[82:83], v13 offset:47968
    ds_read_b64_tr_b16 v[84:85], v12 offset:47232
    ds_read_b64_tr_b16 v[86:87], v12 offset:48000
    s_waitcnt lgkmcnt(11)
    v_mfma_f32_16x16x32_bf16 v[100:103], v[48:51], v[40:43], v[100:103]
    v_mfma_f32_16x16x32_bf16 v[104:107], v[52:55], v[40:43], v[104:107]
    v_mfma_f32_16x16x32_bf16 v[108:111], v[56:59], v[40:43], v[108:111]
    v_mfma_f32_16x16x32_bf16 v[112:115], v[60:63], v[40:43], v[112:115]
    v_mfma_f32_16x16x32_bf16 v[116:119], v[64:67], v[40:43], v[116:119]
    s_waitcnt lgkmcnt(0)
    v_mfma_f32_16x16x32_bf16 v[100:103], v[68:71], v[44:47], v[100:103]
    v_mfma_f32_16x16x32_bf16 v[104:107], v[72:75], v[44:47], v[104:107]
    v_mfma_f32_16x16x32_bf16 v[108:111], v[76:79], v[44:47], v[108:111]
    v_mfma_f32_16x16x32_bf16 v[112:115], v[80:83], v[44:47], v[112:115]
    v_mfma_f32_16x16x32_bf16 v[116:119], v[84:87], v[44:47], v[116:119]
    s_waitcnt vmcnt(20)
    s_barrier
    s_add_u32 m0, s37, 40960
    s_add_u32 s39, s32, 3328
    s_add_u32 s40, s33, 3328
    buffer_load_dwordx4 v3, s[20:23], s39 offen lds
    buffer_load_dwordx4 v4, s[20:23], s40 offen offset:1024 lds
    s_add_u32 m0, s38, 40960
    s_add_u32 s39, s36, 1310720
    buffer_load_dwordx4 v5, s[28:31], s39 offen offset:0 lds
    buffer_load_dwordx4 v6, s[28:31], s39 offen offset:1024 lds
    buffer_load_dwordx4 v7, s[28:31], s39 offen offset:2048 lds
    ds_read_b128 v[40:43], v30 offset:0
    ds_read_b64_tr_b16 v[48:49], v32 offset:0
    ds_read_b64_tr_b16 v[50:51], v32 offset:768
    ds_read_b64_tr_b16 v[52:53], v33 offset:32
    ds_read_b64_tr_b16 v[54:55], v33 offset:800
    ds_read_b64_tr_b16 v[56:57], v32 offset:64
    ds_read_b64_tr_b16 v[58:59], v32 offset:832
    ds_read_b64_tr_b16 v[60:61], v33 offset:96
    ds_read_b64_tr_b16 v[62:63], v33 offset:864
    ds_read_b64_tr_b16 v[64:65], v32 offset:128
    ds_read_b64_tr_b16 v[66:67], v32 offset:896
    ds_read_b128 v[44:47], v31 offset:0
    ds_read_b64_tr_b16 v[68:69], v32 offset:6144
    ds_read_b64_tr_b16 v[70:71], v32 offset:6912
    ds_read_b64_tr_b16 v[72:73], v33 offset:6176
    ds_read_b64_tr_b16 v[74:75], v33 offset:6944
    ds_read_b64_tr_b16 v[76:77], v32 offset:6208
    ds_read_b64_tr_b16 v[78:79], v32 offset:6976
    ds_read_b64_tr_b16 v[80:81], v33 offset:6240
    ds_read_b64_tr_b16 v[82:83], v33 offset:7008
    ds_read_b64_tr_b16 v[84:85], v32 offset:6272
    ds_read_b64_tr_b16 v[86:87], v32 offset:7040
    s_waitcnt lgkmcnt(11)
    v_mfma_f32_16x16x32_bf16 v[100:103], v[48:51], v[40:43], v[100:103]
    v_mfma_f32_16x16x32_bf16 v[104:107], v[52:55], v[40:43], v[104:107]
    v_mfma_f32_16x16x32_bf16 v[108:111], v[56:59], v[40:43], v[108:111]
    v_mfma_f32_16x16x32_bf16 v[112:115], v[60:63], v[40:43], v[112:115]
    v_mfma_f32_16x16x32_bf16 v[116:119], v[64:67], v[40:43], v[116:119]
    s_waitcnt lgkmcnt(0)
    v_mfma_f32_16x16x32_bf16 v[100:103], v[68:71], v[44:47], v[100:103]
    v_mfma_f32_16x16x32_bf16 v[104:107], v[72:75], v[44:47], v[104:107]
    v_mfma_f32_16x16x32_bf16 v[108:111], v[76:79], v[44:47], v[108:111]
    v_mfma_f32_16x16x32_bf16 v[112:115], v[80:83], v[44:47], v[112:115]
    v_mfma_f32_16x16x32_bf16 v[116:119], v[84:87], v[44:47], v[116:119]
    s_waitcnt vmcnt(20)
    s_barrier
    s_add_u32 m0, s37, 61440
    s_add_u32 s39, s32, 3456
    s_add_u32 s40, s33, 3456
    buffer_load_dwordx4 v3, s[20:23], s39 offen lds
    buffer_load_dwordx4 v4, s[20:23], s40 offen offset:1024 lds
    s_add_u32 m0, s38, 61440
    s_add_u32 s39, s36, 1392640
    buffer_load_dwordx4 v5, s[28:31], s39 offen offset:0 lds
    buffer_load_dwordx4 v6, s[28:31], s39 offen offset:1024 lds
    buffer_load_dwordx4 v7, s[28:31], s39 offen offset:2048 lds
    ds_read_b128 v[40:43], v30 offset:20480
    ds_read_b64_tr_b16 v[48:49], v32 offset:20480
    ds_read_b64_tr_b16 v[50:51], v32 offset:21248
    ds_read_b64_tr_b16 v[52:53], v33 offset:20512
    ds_read_b64_tr_b16 v[54:55], v33 offset:21280
    ds_read_b64_tr_b16 v[56:57], v32 offset:20544
    ds_read_b64_tr_b16 v[58:59], v32 offset:21312
    ds_read_b64_tr_b16 v[60:61], v33 offset:20576
    ds_read_b64_tr_b16 v[62:63], v33 offset:21344
    ds_read_b64_tr_b16 v[64:65], v32 offset:20608
    ds_read_b64_tr_b16 v[66:67], v32 offset:21376
    ds_read_b128 v[44:47], v31 offset:20480
    ds_read_b64_tr_b16 v[68:69], v32 offset:26624
    ds_read_b64_tr_b16 v[70:71], v32 offset:27392
    ds_read_b64_tr_b16 v[72:73], v33 offset:26656
    ds_read_b64_tr_b16 v[74:75], v33 offset:27424
    ds_read_b64_tr_b16 v[76:77], v32 offset:26688
    ds_read_b64_tr_b16 v[78:79], v32 offset:27456
    ds_read_b64_tr_b16 v[80:81], v33 offset:26720
    ds_read_b64_tr_b16 v[82:83], v33 offset:27488
    ds_read_b64_tr_b16 v[84:85], v32 offset:26752
    ds_read_b64_tr_b16 v[86:87], v32 offset:27520
    s_waitcnt lgkmcnt(11)
    v_mfma_f32_16x16x32_bf16 v[100:103], v[48:51], v[40:43], v[100:103]
    v_mfma_f32_16x16x32_bf16 v[104:107], v[52:55], v[40:43], v[104:107]
    v_mfma_f32_16x16x32_bf16 v[108:111], v[56:59], v[40:43], v[108:111]
    v_mfma_f32_16x16x32_bf16 v[112:115], v[60:63], v[40:43], v[112:115]
    v_mfma_f32_16x16x32_bf16 v[116:119], v[64:67], v[40:43], v[116:119]
    s_waitcnt lgkmcnt(0)
    v_mfma_f32_16x16x32_bf16 v[100:103], v[68:71], v[44:47], v[100:103]
    v_mfma_f32_16x16x32_bf16 v[104:107], v[72:75], v[44:47], v[104:107]
    v_mfma_f32_16x16x32_bf16 v[108:111], v[76:79], v[44:47], v[108:111]
    v_mfma_f32_16x16x32_bf16 v[112:115], v[80:83], v[44:47], v[112:115]
    v_mfma_f32_16x16x32_bf16 v[116:119], v[84:87], v[44:47], v[116:119]
    s_waitcnt vmcnt(20)
    s_barrier
    s_add_u32 m0, s37, 81920
    s_add_u32 s39, s32, 3584
    s_add_u32 s40, s33, 3584
    buffer_load_dwordx4 v3, s[20:23], s39 offen lds
    buffer_load_dwordx4 v4, s[20:23], s40 offen offset:1024 lds
    s_add_u32 m0, s38, 81920
    s_add_u32 s39, s36, 1474560
    buffer_load_dwordx4 v5, s[28:31], s39 offen offset:0 lds
    buffer_load_dwordx4 v6, s[28:31], s39 offen offset:1024 lds
    buffer_load_dwordx4 v7, s[28:31], s39 offen offset:2048 lds
    ds_read_b128 v[40:43], v30 offset:40960
    ds_read_b64_tr_b16 v[48:49], v32 offset:40960
    ds_read_b64_tr_b16 v[50:51], v32 offset:41728
    ds_read_b64_tr_b16 v[52:53], v33 offset:40992
    ds_read_b64_tr_b16 v[54:55], v33 offset:41760
    ds_read_b64_tr_b16 v[56:57], v32 offset:41024
    ds_read_b64_tr_b16 v[58:59], v32 offset:41792
    ds_read_b64_tr_b16 v[60:61], v33 offset:41056
    ds_read_b64_tr_b16 v[62:63], v33 offset:41824
    ds_read_b64_tr_b16 v[64:65], v32 offset:41088
    ds_read_b64_tr_b16 v[66:67], v32 offset:41856
    ds_read_b128 v[44:47], v31 offset:40960
    ds_read_b64_tr_b16 v[68:69], v32 offset:47104
    ds_read_b64_tr_b16 v[70:71], v32 offset:47872
    ds_read_b64_tr_b16 v[72:73], v33 offset:47136
    ds_read_b64_tr_b16 v[74:75], v33 offset:47904
    ds_read_b64_tr_b16 v[76:77], v32 offset:47168
    ds_read_b64_tr_b16 v[78:79], v32 offset:47936
    ds_read_b64_tr_b16 v[80:81], v33 offset:47200
    ds_read_b64_tr_b16 v[82:83], v33 offset:47968
    ds_read_b64_tr_b16 v[84:85], v32 offset:47232
    ds_read_b64_tr_b16 v[86:87], v32 offset:48000
    s_waitcnt lgkmcnt(11)
    v_mfma_f32_16x16x32_bf16 v[100:103], v[48:51], v[40:43], v[100:103]
    v_mfma_f32_16x16x32_bf16 v[104:107], v[52:55], v[40:43], v[104:107]
    v_mfma_f32_16x16x32_bf16 v[108:111], v[56:59], v[40:43], v[108:111]
    v_mfma_f32_16x16x32_bf16 v[112:115], v[60:63], v[40:43], v[112:115]
    v_mfma_f32_16x16x32_bf16 v[116:119], v[64:67], v[40:43], v[116:119]
    s_waitcnt lgkmcnt(0)
    v_mfma_f32_16x16x32_bf16 v[100:103], v[68:71], v[44:47], v[100:103]
    v_mfma_f32_16x16x32_bf16 v[104:107], v[72:75], v[44:47], v[104:107]
    v_mfma_f32_16x16x32_bf16 v[108:111], v[76:79], v[44:47], v[108:111]
    v_mfma_f32_16x16x32_bf16 v[112:115], v[80:83], v[44:47], v[112:115]
    v_mfma_f32_16x16x32_bf16 v[116:119], v[84:87], v[44:47], v[116:119]
    s_waitcnt vmcnt(20)
    s_barrier
    s_add_u32 m0, s37, 102400
    s_add_u32 s39, s32, 3712
    s_add_u32 s40, s33, 3712
    buffer_load_dwordx4 v3, s[20:23], s39 offen lds
    buffer_load_dwordx4 v4, s[20:23], s40 offen offset:1024 lds
    s_add_u32 m0, s38, 102400
    s_add_u32 s39, s36, 1556480
    buffer_load_dwordx4 v5, s[28:31], s39 offen offset:0 lds
    buffer_load_dwordx4 v6, s[28:31], s39 offen offset:1024 lds
    buffer_load_dwordx4 v7, s[28:31], s39 offen offset:2048 lds
    ds_read_b128 v[40:43], v10 offset:0
    ds_read_b64_tr_b16 v[48:49], v12 offset:0
    ds_read_b64_tr_b16 v[50:51], v12 offset:768
    ds_read_b64_tr_b16 v[52:53], v13 offset:32
    ds_read_b64_tr_b16 v[54:55], v13 offset:800
    ds_read_b64_tr_b16 v[56:57], v12 offset:64
    ds_read_b64_tr_b16 v[58:59], v12 offset:832
    ds_read_b64_tr_b16 v[60:61], v13 offset:96
    ds_read_b64_tr_b16 v[62:63], v13 offset:864
    ds_read_b64_tr_b16 v[64:65], v12 offset:128
    ds_read_b64_tr_b16 v[66:67], v12 offset:896
    ds_read_b128 v[44:47], v11 offset:0
    ds_read_b64_tr_b16 v[68:69], v12 offset:6144
    ds_read_b64_tr_b16 v[70:71], v12 offset:6912
    ds_read_b64_tr_b16 v[72:73], v13 offset:6176
    ds_read_b64_tr_b16 v[74:75], v13 offset:6944
    ds_read_b64_tr_b16 v[76:77], v12 offset:6208
    ds_read_b64_tr_b16 v[78:79], v12 offset:6976
    ds_read_b64_tr_b16 v[80:81], v13 offset:6240
    ds_read_b64_tr_b16 v[82:83], v13 offset:7008
    ds_read_b64_tr_b16 v[84:85], v12 offset:6272
    ds_read_b64_tr_b16 v[86:87], v12 offset:7040
    s_waitcnt lgkmcnt(11)
    v_mfma_f32_16x16x32_bf16 v[100:103], v[48:51], v[40:43], v[100:103]
    v_mfma_f32_16x16x32_bf16 v[104:107], v[52:55], v[40:43], v[104:107]
    v_mfma_f32_16x16x32_bf16 v[108:111], v[56:59], v[40:43], v[108:111]
    v_mfma_f32_16x16x32_bf16 v[112:115], v[60:63], v[40:43], v[112:115]
    v_mfma_f32_16x16x32_bf16 v[116:119], v[64:67], v[40:43], v[116:119]
    s_waitcnt lgkmcnt(0)
    v_mfma_f32_16x16x32_bf16 v[100:103], v[68:71], v[44:47], v[100:103]
    v_mfma_f32_16x16x32_bf16 v[104:107], v[72:75], v[44:47], v[104:107]
    v_mfma_f32_16x16x32_bf16 v[108:111], v[76:79], v[44:47], v[108:111]
    v_mfma_f32_16x16x32_bf16 v[112:115], v[80:83], v[44:47], v[112:115]
    v_mfma_f32_16x16x32_bf16 v[116:119], v[84:87], v[44:47], v[116:119]
    s_waitcnt vmcnt(20)
    s_barrier
    s_add_u32 m0, s37, 0
    s_add_u32 s39, s32, 3840
    s_add_u32 s40, s33, 3840
    buffer_load_dwordx4 v3, s[20:23], s39 offen lds
    buffer_load_dwordx4 v4, s[20:23], s40 offen offset:1024 lds
    s_add_u32 m0, s38, 0
    s_add_u32 s39, s36, 1638400
    buffer_load_dwordx4 v5, s[28:31], s39 offen offset:0 lds
    buffer_load_dwordx4 v6, s[28:31], s39 offen offset:1024 lds
    buffer_load_dwordx4 v7, s[28:31], s39 offen offset:2048 lds
    ds_read_b128 v[40:43], v10 offset:20480
    ds_read_b64_tr_b16 v[48:49], v12 offset:20480
    ds_read_b64_tr_b16 v[50:51], v12 offset:21248
    ds_read_b64_tr_b16 v[52:53], v13 offset:20512
    ds_read_b64_tr_b16 v[54:55], v13 offset:21280
    ds_read_b64_tr_b16 v[56:57], v12 offset:20544
    ds_read_b64_tr_b16 v[58:59], v12 offset:21312
    ds_read_b64_tr_b16 v[60:61], v13 offset:20576
    ds_read_b64_tr_b16 v[62:63], v13 offset:21344
    ds_read_b64_tr_b16 v[64:65], v12 offset:20608
    ds_read_b64_tr_b16 v[66:67], v12 offset:21376
    ds_read_b128 v[44:47], v11 offset:20480
    ds_read_b64_tr_b16 v[68:69], v12 offset:26624
    ds_read_b64_tr_b16 v[70:71], v12 offset:27392
    ds_read_b64_tr_b16 v[72:73], v13 offset:26656
    ds_read_b64_tr_b16 v[74:75], v13 offset:27424
    ds_read_b64_tr_b16 v[76:77], v12 offset:26688
    ds_read_b64_tr_b16 v[78:79], v12 offset:27456
    ds_read_b64_tr_b16 v[80:81], v13 offset:26720
    ds_read_b64_tr_b16 v[82:83], v13 offset:27488
    ds_read_b64_tr_b16 v[84:85], v12 offset:26752
    ds_read_b64_tr_b16 v[86:87], v12 offset:27520
    s_waitcnt lgkmcnt(11)
    v_mfma_f32_16x16x32_bf16 v[100:103], v[48:51], v[40:43], v[100:103]
    v_mfma_f32_16x16x32_bf16 v[104:107], v[52:55], v[40:43], v[104:107]
    v_mfma_f32_16x16x32_bf16 v[108:111], v[56:59], v[40:43], v[108:111]
    v_mfma_f32_16x16x32_bf16 v[112:115], v[60:63], v[40:43], v[112:115]
    v_mfma_f32_16x16x32_bf16 v[116:119], v[64:67], v[40:43], v[116:119]
    s_waitcnt lgkmcnt(0)
    v_mfma_f32_16x16x32_bf16 v[100:103], v[68:71], v[44:47], v[100:103]
    v_mfma_f32_16x16x32_bf16 v[104:107], v[72:75], v[44:47], v[104:107]
    v_mfma_f32_16x16x32_bf16 v[108:111], v[76:79], v[44:47], v[108:111]
    v_mfma_f32_16x16x32_bf16 v[112:115], v[80:83], v[44:47], v[112:115]
    v_mfma_f32_16x16x32_bf16 v[116:119], v[84:87], v[44:47], v[116:119]
    s_waitcnt vmcnt(20)
    s_barrier
    s_add_u32 m0, s37, 20480
    s_add_u32 s39, s32, 3968
    s_add_u32 s40, s33, 3968
    buffer_load_dwordx4 v3, s[20:23], s39 offen lds
    buffer_load_dwordx4 v4, s[20:23], s40 offen offset:1024 lds
    s_add_u32 m0, s38, 20480
    s_add_u32 s39, s36, 1720320
    buffer_load_dwordx4 v5, s[28:31], s39 offen offset:0 lds
    buffer_load_dwordx4 v6, s[28:31], s39 offen offset:1024 lds
    buffer_load_dwordx4 v7, s[28:31], s39 offen offset:2048 lds
    ds_read_b128 v[40:43], v10 offset:40960
    ds_read_b64_tr_b16 v[48:49], v12 offset:40960
    ds_read_b64_tr_b16 v[50:51], v12 offset:41728
    ds_read_b64_tr_b16 v[52:53], v13 offset:40992
    ds_read_b64_tr_b16 v[54:55], v13 offset:41760
    ds_read_b64_tr_b16 v[56:57], v12 offset:41024
    ds_read_b64_tr_b16 v[58:59], v12 offset:41792
    ds_read_b64_tr_b16 v[60:61], v13 offset:41056
    ds_read_b64_tr_b16 v[62:63], v13 offset:41824
    ds_read_b64_tr_b16 v[64:65], v12 offset:41088
    ds_read_b64_tr_b16 v[66:67], v12 offset:41856
    ds_read_b128 v[44:47], v11 offset:40960
    ds_read_b64_tr_b16 v[68:69], v12 offset:47104
    ds_read_b64_tr_b16 v[70:71], v12 offset:47872
    ds_read_b64_tr_b16 v[72:73], v13 offset:47136
    ds_read_b64_tr_b16 v[74:75], v13 offset:47904
    ds_read_b64_tr_b16 v[76:77], v12 offset:47168
    ds_read_b64_tr_b16 v[78:79], v12 offset:47936
    ds_read_b64_tr_b16 v[80:81], v13 offset:47200
    ds_read_b64_tr_b16 v[82:83], v13 offset:47968
    ds_read_b64_tr_b16 v[84:85], v12 offset:47232
    ds_read_b64_tr_b16 v[86:87], v12 offset:48000
    s_waitcnt lgkmcnt(11)
    v_mfma_f32_16x16x32_bf16 v[100:103], v[48:51], v[40:43], v[100:103]
    v_mfma_f32_16x16x32_bf16 v[104:107], v[52:55], v[40:43], v[104:107]
    v_mfma_f32_16x16x32_bf16 v[108:111], v[56:59], v[40:43], v[108:111]
    v_mfma_f32_16x16x32_bf16 v[112:115], v[60:63], v[40:43], v[112:115]
    v_mfma_f32_16x16x32_bf16 v[116:119], v[64:67], v[40:43], v[116:119]
    s_waitcnt lgkmcnt(0)
    v_mfma_f32_16x16x32_bf16 v[100:103], v[68:71], v[44:47], v[100:103]
    v_mfma_f32_16x16x32_bf16 v[104:107], v[72:75], v[44:47], v[104:107]
    v_mfma_f32_16x16x32_bf16 v[108:111], v[76:79], v[44:47], v[108:111]
    v_mfma_f32_16x16x32_bf16 v[112:115], v[80:83], v[44:47], v[112:115]
    v_mfma_f32_16x16x32_bf16 v[116:119], v[84:87], v[44:47], v[116:119]
    s_waitcnt vmcnt(20)
    s_barrier
    s_add_u32 m0, s37, 40960
    s_add_u32 s39, s32, 4096
    s_add_u32 s40, s33, 4096
    buffer_load_dwordx4 v3, s[20:23], s39 offen lds
    buffer_load_dwordx4 v4, s[20:23], s40 offen offset:1024 lds
    s_add_u32 m0, s38, 40960
    s_add_u32 s39, s36, 1802240
    buffer_load_dwordx4 v5, s[28:31], s39 offen offset:0 lds
    buffer_load_dwordx4 v6, s[28:31], s39 offen offset:1024 lds
    buffer_load_dwordx4 v7, s[28:31], s39 offen offset:2048 lds
    ds_read_b128 v[40:43], v30 offset:0
    ds_read_b64_tr_b16 v[48:49], v32 offset:0
    ds_read_b64_tr_b16 v[50:51], v32 offset:768
    ds_read_b64_tr_b16 v[52:53], v33 offset:32
    ds_read_b64_tr_b16 v[54:55], v33 offset:800
    ds_read_b64_tr_b16 v[56:57], v32 offset:64
    ds_read_b64_tr_b16 v[58:59], v32 offset:832
    ds_read_b64_tr_b16 v[60:61], v33 offset:96
    ds_read_b64_tr_b16 v[62:63], v33 offset:864
    ds_read_b64_tr_b16 v[64:65], v32 offset:128
    ds_read_b64_tr_b16 v[66:67], v32 offset:896
    ds_read_b128 v[44:47], v31 offset:0
    ds_read_b64_tr_b16 v[68:69], v32 offset:6144
    ds_read_b64_tr_b16 v[70:71], v32 offset:6912
    ds_read_b64_tr_b16 v[72:73], v33 offset:6176
    ds_read_b64_tr_b16 v[74:75], v33 offset:6944
    ds_read_b64_tr_b16 v[76:77], v32 offset:6208
    ds_read_b64_tr_b16 v[78:79], v32 offset:6976
    ds_read_b64_tr_b16 v[80:81], v33 offset:6240
    ds_read_b64_tr_b16 v[82:83], v33 offset:7008
    ds_read_b64_tr_b16 v[84:85], v32 offset:6272
    ds_read_b64_tr_b16 v[86:87], v32 offset:7040
    s_waitcnt lgkmcnt(11)
    v_mfma_f32_16x16x32_bf16 v[100:103], v[48:51], v[40:43], v[100:103]
    v_mfma_f32_16x16x32_bf16 v[104:107], v[52:55], v[40:43], v[104:107]
    v_mfma_f32_16x16x32_bf16 v[108:111], v[56:59], v[40:43], v[108:111]
    v_mfma_f32_16x16x32_bf16 v[112:115], v[60:63], v[40:43], v[112:115]
    v_mfma_f32_16x16x32_bf16 v[116:119], v[64:67], v[40:43], v[116:119]
    s_waitcnt lgkmcnt(0)
    v_mfma_f32_16x16x32_bf16 v[100:103], v[68:71], v[44:47], v[100:103]
    v_mfma_f32_16x16x32_bf16 v[104:107], v[72:75], v[44:47], v[104:107]
    v_mfma_f32_16x16x32_bf16 v[108:111], v[76:79], v[44:47], v[108:111]
    v_mfma_f32_16x16x32_bf16 v[112:115], v[80:83], v[44:47], v[112:115]
    v_mfma_f32_16x16x32_bf16 v[116:119], v[84:87], v[44:47], v[116:119]
    s_waitcnt vmcnt(20)
    s_barrier
    s_add_u32 m0, s37, 61440
    s_add_u32 s39, s32, 4224
    s_add_u32 s40, s33, 4224
    buffer_load_dwordx4 v3, s[20:23], s39 offen lds
    buffer_load_dwordx4 v4, s[20:23], s40 offen offset:1024 lds
    s_add_u32 m0, s38, 61440
    s_add_u32 s39, s36, 1884160
    buffer_load_dwordx4 v5, s[28:31], s39 offen offset:0 lds
    buffer_load_dwordx4 v6, s[28:31], s39 offen offset:1024 lds
    buffer_load_dwordx4 v7, s[28:31], s39 offen offset:2048 lds
    ds_read_b128 v[40:43], v30 offset:20480
    ds_read_b64_tr_b16 v[48:49], v32 offset:20480
    ds_read_b64_tr_b16 v[50:51], v32 offset:21248
    ds_read_b64_tr_b16 v[52:53], v33 offset:20512
    ds_read_b64_tr_b16 v[54:55], v33 offset:21280
    ds_read_b64_tr_b16 v[56:57], v32 offset:20544
    ds_read_b64_tr_b16 v[58:59], v32 offset:21312
    ds_read_b64_tr_b16 v[60:61], v33 offset:20576
    ds_read_b64_tr_b16 v[62:63], v33 offset:21344
    ds_read_b64_tr_b16 v[64:65], v32 offset:20608
    ds_read_b64_tr_b16 v[66:67], v32 offset:21376
    ds_read_b128 v[44:47], v31 offset:20480
    ds_read_b64_tr_b16 v[68:69], v32 offset:26624
    ds_read_b64_tr_b16 v[70:71], v32 offset:27392
    ds_read_b64_tr_b16 v[72:73], v33 offset:26656
    ds_read_b64_tr_b16 v[74:75], v33 offset:27424
    ds_read_b64_tr_b16 v[76:77], v32 offset:26688
    ds_read_b64_tr_b16 v[78:79], v32 offset:27456
    ds_read_b64_tr_b16 v[80:81], v33 offset:26720
    ds_read_b64_tr_b16 v[82:83], v33 offset:27488
    ds_read_b64_tr_b16 v[84:85], v32 offset:26752
    ds_read_b64_tr_b16 v[86:87], v32 offset:27520
    s_waitcnt lgkmcnt(11)
    v_mfma_f32_16x16x32_bf16 v[100:103], v[48:51], v[40:43], v[100:103]
    v_mfma_f32_16x16x32_bf16 v[104:107], v[52:55], v[40:43], v[104:107]
    v_mfma_f32_16x16x32_bf16 v[108:111], v[56:59], v[40:43], v[108:111]
    v_mfma_f32_16x16x32_bf16 v[112:115], v[60:63], v[40:43], v[112:115]
    v_mfma_f32_16x16x32_bf16 v[116:119], v[64:67], v[40:43], v[116:119]
    s_waitcnt lgkmcnt(0)
    v_mfma_f32_16x16x32_bf16 v[100:103], v[68:71], v[44:47], v[100:103]
    v_mfma_f32_16x16x32_bf16 v[104:107], v[72:75], v[44:47], v[104:107]
    v_mfma_f32_16x16x32_bf16 v[108:111], v[76:79], v[44:47], v[108:111]
    v_mfma_f32_16x16x32_bf16 v[112:115], v[80:83], v[44:47], v[112:115]
    v_mfma_f32_16x16x32_bf16 v[116:119], v[84:87], v[44:47], v[116:119]
    s_waitcnt vmcnt(20)
    s_barrier
    s_add_u32 m0, s37, 81920
    s_add_u32 s39, s32, 4352
    s_add_u32 s40, s33, 4352
    buffer_load_dwordx4 v3, s[20:23], s39 offen lds
    buffer_load_dwordx4 v4, s[20:23], s40 offen offset:1024 lds
    s_add_u32 m0, s38, 81920
    s_add_u32 s39, s36, 1966080
    buffer_load_dwordx4 v5, s[28:31], s39 offen offset:0 lds
    buffer_load_dwordx4 v6, s[28:31], s39 offen offset:1024 lds
    buffer_load_dwordx4 v7, s[28:31], s39 offen offset:2048 lds
    ds_read_b128 v[40:43], v30 offset:40960
    ds_read_b64_tr_b16 v[48:49], v32 offset:40960
    ds_read_b64_tr_b16 v[50:51], v32 offset:41728
    ds_read_b64_tr_b16 v[52:53], v33 offset:40992
    ds_read_b64_tr_b16 v[54:55], v33 offset:41760
    ds_read_b64_tr_b16 v[56:57], v32 offset:41024
    ds_read_b64_tr_b16 v[58:59], v32 offset:41792
    ds_read_b64_tr_b16 v[60:61], v33 offset:41056
    ds_read_b64_tr_b16 v[62:63], v33 offset:41824
    ds_read_b64_tr_b16 v[64:65], v32 offset:41088
    ds_read_b64_tr_b16 v[66:67], v32 offset:41856
    ds_read_b128 v[44:47], v31 offset:40960
    ds_read_b64_tr_b16 v[68:69], v32 offset:47104
    ds_read_b64_tr_b16 v[70:71], v32 offset:47872
    ds_read_b64_tr_b16 v[72:73], v33 offset:47136
    ds_read_b64_tr_b16 v[74:75], v33 offset:47904
    ds_read_b64_tr_b16 v[76:77], v32 offset:47168
    ds_read_b64_tr_b16 v[78:79], v32 offset:47936
    ds_read_b64_tr_b16 v[80:81], v33 offset:47200
    ds_read_b64_tr_b16 v[82:83], v33 offset:47968
    ds_read_b64_tr_b16 v[84:85], v32 offset:47232
    ds_read_b64_tr_b16 v[86:87], v32 offset:48000
    s_waitcnt lgkmcnt(11)
    v_mfma_f32_16x16x32_bf16 v[100:103], v[48:51], v[40:43], v[100:103]
    v_mfma_f32_16x16x32_bf16 v[104:107], v[52:55], v[40:43], v[104:107]
    v_mfma_f32_16x16x32_bf16 v[108:111], v[56:59], v[40:43], v[108:111]
    v_mfma_f32_16x16x32_bf16 v[112:115], v[60:63], v[40:43], v[112:115]
    v_mfma_f32_16x16x32_bf16 v[116:119], v[64:67], v[40:43], v[116:119]
    s_waitcnt lgkmcnt(0)
    v_mfma_f32_16x16x32_bf16 v[100:103], v[68:71], v[44:47], v[100:103]
    v_mfma_f32_16x16x32_bf16 v[104:107], v[72:75], v[44:47], v[104:107]
    v_mfma_f32_16x16x32_bf16 v[108:111], v[76:79], v[44:47], v[108:111]
    v_mfma_f32_16x16x32_bf16 v[112:115], v[80:83], v[44:47], v[112:115]
    v_mfma_f32_16x16x32_bf16 v[116:119], v[84:87], v[44:47], v[116:119]
    s_waitcnt vmcnt(20)
    s_barrier
    s_add_u32 m0, s37, 102400
    s_add_u32 s39, s32, 4480
    s_add_u32 s40, s33, 4480
    buffer_load_dwordx4 v3, s[20:23], s39 offen lds
    buffer_load_dwordx4 v4, s[20:23], s40 offen offset:1024 lds
    s_add_u32 m0, s38, 102400
    s_add_u32 s39, s36, 2048000
    buffer_load_dwordx4 v5, s[28:31], s39 offen offset:0 lds
    buffer_load_dwordx4 v6, s[28:31], s39 offen offset:1024 lds
    buffer_load_dwordx4 v7, s[28:31], s39 offen offset:2048 lds
    ds_read_b128 v[40:43], v10 offset:0
    ds_read_b64_tr_b16 v[48:49], v12 offset:0
    ds_read_b64_tr_b16 v[50:51], v12 offset:768
    ds_read_b64_tr_b16 v[52:53], v13 offset:32
    ds_read_b64_tr_b16 v[54:55], v13 offset:800
    ds_read_b64_tr_b16 v[56:57], v12 offset:64
    ds_read_b64_tr_b16 v[58:59], v12 offset:832
    ds_read_b64_tr_b16 v[60:61], v13 offset:96
    ds_read_b64_tr_b16 v[62:63], v13 offset:864
    ds_read_b64_tr_b16 v[64:65], v12 offset:128
    ds_read_b64_tr_b16 v[66:67], v12 offset:896
    ds_read_b128 v[44:47], v11 offset:0
    ds_read_b64_tr_b16 v[68:69], v12 offset:6144
    ds_read_b64_tr_b16 v[70:71], v12 offset:6912
    ds_read_b64_tr_b16 v[72:73], v13 offset:6176
    ds_read_b64_tr_b16 v[74:75], v13 offset:6944
    ds_read_b64_tr_b16 v[76:77], v12 offset:6208
    ds_read_b64_tr_b16 v[78:79], v12 offset:6976
    ds_read_b64_tr_b16 v[80:81], v13 offset:6240
    ds_read_b64_tr_b16 v[82:83], v13 offset:7008
    ds_read_b64_tr_b16 v[84:85], v12 offset:6272
    ds_read_b64_tr_b16 v[86:87], v12 offset:7040
    s_waitcnt lgkmcnt(11)
    v_mfma_f32_16x16x32_bf16 v[100:103], v[48:51], v[40:43], v[100:103]
    v_mfma_f32_16x16x32_bf16 v[104:107], v[52:55], v[40:43], v[104:107]
    v_mfma_f32_16x16x32_bf16 v[108:111], v[56:59], v[40:43], v[108:111]
    v_mfma_f32_16x16x32_bf16 v[112:115], v[60:63], v[40:43], v[112:115]
    v_mfma_f32_16x16x32_bf16 v[116:119], v[64:67], v[40:43], v[116:119]
    s_waitcnt lgkmcnt(0)
    v_mfma_f32_16x16x32_bf16 v[100:103], v[68:71], v[44:47], v[100:103]
    v_mfma_f32_16x16x32_bf16 v[104:107], v[72:75], v[44:47], v[104:107]
    v_mfma_f32_16x16x32_bf16 v[108:111], v[76:79], v[44:47], v[108:111]
    v_mfma_f32_16x16x32_bf16 v[112:115], v[80:83], v[44:47], v[112:115]
    v_mfma_f32_16x16x32_bf16 v[116:119], v[84:87], v[44:47], v[116:119]
    s_waitcnt vmcnt(20)
    s_barrier
    s_add_u32 m0, s37, 0
    s_add_u32 s39, s32, 4608
    s_add_u32 s40, s33, 4608
    buffer_load_dwordx4 v3, s[20:23], s39 offen lds
    buffer_load_dwordx4 v4, s[20:23], s40 offen offset:1024 lds
    s_add_u32 m0, s38, 0
    s_add_u32 s39, s36, 2129920
    buffer_load_dwordx4 v5, s[28:31], s39 offen offset:0 lds
    buffer_load_dwordx4 v6, s[28:31], s39 offen offset:1024 lds
    buffer_load_dwordx4 v7, s[28:31], s39 offen offset:2048 lds
    ds_read_b128 v[40:43], v10 offset:20480
    ds_read_b64_tr_b16 v[48:49], v12 offset:20480
    ds_read_b64_tr_b16 v[50:51], v12 offset:21248
    ds_read_b64_tr_b16 v[52:53], v13 offset:20512
    ds_read_b64_tr_b16 v[54:55], v13 offset:21280
    ds_read_b64_tr_b16 v[56:57], v12 offset:20544
    ds_read_b64_tr_b16 v[58:59], v12 offset:21312
    ds_read_b64_tr_b16 v[60:61], v13 offset:20576
    ds_read_b64_tr_b16 v[62:63], v13 offset:21344
    ds_read_b64_tr_b16 v[64:65], v12 offset:20608
    ds_read_b64_tr_b16 v[66:67], v12 offset:21376
    ds_read_b128 v[44:47], v11 offset:20480
    ds_read_b64_tr_b16 v[68:69], v12 offset:26624
    ds_read_b64_tr_b16 v[70:71], v12 offset:27392
    ds_read_b64_tr_b16 v[72:73], v13 offset:26656
    ds_read_b64_tr_b16 v[74:75], v13 offset:27424
    ds_read_b64_tr_b16 v[76:77], v12 offset:26688
    ds_read_b64_tr_b16 v[78:79], v12 offset:27456
    ds_read_b64_tr_b16 v[80:81], v13 offset:26720
    ds_read_b64_tr_b16 v[82:83], v13 offset:27488
    ds_read_b64_tr_b16 v[84:85], v12 offset:26752
    ds_read_b64_tr_b16 v[86:87], v12 offset:27520
    s_waitcnt lgkmcnt(11)
    v_mfma_f32_16x16x32_bf16 v[100:103], v[48:51], v[40:43], v[100:103]
    v_mfma_f32_16x16x32_bf16 v[104:107], v[52:55], v[40:43], v[104:107]
    v_mfma_f32_16x16x32_bf16 v[108:111], v[56:59], v[40:43], v[108:111]
    v_mfma_f32_16x16x32_bf16 v[112:115], v[60:63], v[40:43], v[112:115]
    v_mfma_f32_16x16x32_bf16 v[116:119], v[64:67], v[40:43], v[116:119]
    s_waitcnt lgkmcnt(0)
    v_mfma_f32_16x16x32_bf16 v[100:103], v[68:71], v[44:47], v[100:103]
    v_mfma_f32_16x16x32_bf16 v[104:107], v[72:75], v[44:47], v[104:107]
    v_mfma_f32_16x16x32_bf16 v[108:111], v[76:79], v[44:47], v[108:111]
    v_mfma_f32_16x16x32_bf16 v[112:115], v[80:83], v[44:47], v[112:115]
    v_mfma_f32_16x16x32_bf16 v[116:119], v[84:87], v[44:47], v[116:119]
    s_waitcnt vmcnt(20)
    s_barrier
    ds_read_b128 v[40:43], v10 offset:40960
    ds_read_b64_tr_b16 v[48:49], v12 offset:40960
    ds_read_b64_tr_b16 v[50:51], v12 offset:41728
    ds_read_b64_tr_b16 v[52:53], v13 offset:40992
    ds_read_b64_tr_b16 v[54:55], v13 offset:41760
    ds_read_b64_tr_b16 v[56:57], v12 offset:41024
    ds_read_b64_tr_b16 v[58:59], v12 offset:41792
    ds_read_b64_tr_b16 v[60:61], v13 offset:41056
    ds_read_b64_tr_b16 v[62:63], v13 offset:41824
    ds_read_b64_tr_b16 v[64:65], v12 offset:41088
    ds_read_b64_tr_b16 v[66:67], v12 offset:41856
    ds_read_b128 v[44:47], v11 offset:40960
    ds_read_b64_tr_b16 v[68:69], v12 offset:47104
    ds_read_b64_tr_b16 v[70:71], v12 offset:47872
    ds_read_b64_tr_b16 v[72:73], v13 offset:47136
    ds_read_b64_tr_b16 v[74:75], v13 offset:47904
    ds_read_b64_tr_b16 v[76:77], v12 offset:47168
    ds_read_b64_tr_b16 v[78:79], v12 offset:47936
    ds_read_b64_tr_b16 v[80:81], v13 offset:47200
    ds_read_b64_tr_b16 v[82:83], v13 offset:47968
    ds_read_b64_tr_b16 v[84:85], v12 offset:47232
    ds_read_b64_tr_b16 v[86:87], v12 offset:48000
    s_waitcnt lgkmcnt(11)
    v_mfma_f32_16x16x32_bf16 v[100:103], v[48:51], v[40:43], v[100:103]
    v_mfma_f32_16x16x32_bf16 v[104:107], v[52:55], v[40:43], v[104:107]
    v_mfma_f32_16x16x32_bf16 v[108:111], v[56:59], v[40:43], v[108:111]
    v_mfma_f32_16x16x32_bf16 v[112:115], v[60:63], v[40:43], v[112:115]
    v_mfma_f32_16x16x32_bf16 v[116:119], v[64:67], v[40:43], v[116:119]
    s_waitcnt lgkmcnt(0)
    v_mfma_f32_16x16x32_bf16 v[100:103], v[68:71], v[44:47], v[100:103]
    v_mfma_f32_16x16x32_bf16 v[104:107], v[72:75], v[44:47], v[104:107]
    v_mfma_f32_16x16x32_bf16 v[108:111], v[76:79], v[44:47], v[108:111]
    v_mfma_f32_16x16x32_bf16 v[112:115], v[80:83], v[44:47], v[112:115]
    v_mfma_f32_16x16x32_bf16 v[116:119], v[84:87], v[44:47], v[116:119]
    s_waitcnt vmcnt(15)
    s_barrier
    ds_read_b128 v[40:43], v30 offset:0
    ds_read_b64_tr_b16 v[48:49], v32 offset:0
    ds_read_b64_tr_b16 v[50:51], v32 offset:768
    ds_read_b64_tr_b16 v[52:53], v33 offset:32
    ds_read_b64_tr_b16 v[54:55], v33 offset:800
    ds_read_b64_tr_b16 v[56:57], v32 offset:64
    ds_read_b64_tr_b16 v[58:59], v32 offset:832
    ds_read_b64_tr_b16 v[60:61], v33 offset:96
    ds_read_b64_tr_b16 v[62:63], v33 offset:864
    ds_read_b64_tr_b16 v[64:65], v32 offset:128
    ds_read_b64_tr_b16 v[66:67], v32 offset:896
    ds_read_b128 v[44:47], v31 offset:0
    ds_read_b64_tr_b16 v[68:69], v32 offset:6144
    ds_read_b64_tr_b16 v[70:71], v32 offset:6912
    ds_read_b64_tr_b16 v[72:73], v33 offset:6176
    ds_read_b64_tr_b16 v[74:75], v33 offset:6944
    ds_read_b64_tr_b16 v[76:77], v32 offset:6208
    ds_read_b64_tr_b16 v[78:79], v32 offset:6976
    ds_read_b64_tr_b16 v[80:81], v33 offset:6240
    ds_read_b64_tr_b16 v[82:83], v33 offset:7008
    ds_read_b64_tr_b16 v[84:85], v32 offset:6272
    ds_read_b64_tr_b16 v[86:87], v32 offset:7040
    s_waitcnt lgkmcnt(11)
    v_mfma_f32_16x16x32_bf16 v[100:103], v[48:51], v[40:43], v[100:103]
    v_mfma_f32_16x16x32_bf16 v[104:107], v[52:55], v[40:43], v[104:107]
    v_mfma_f32_16x16x32_bf16 v[108:111], v[56:59], v[40:43], v[108:111]
    v_mfma_f32_16x16x32_bf16 v[112:115], v[60:63], v[40:43], v[112:115]
    v_mfma_f32_16x16x32_bf16 v[116:119], v[64:67], v[40:43], v[116:119]
    s_waitcnt lgkmcnt(0)
    v_mfma_f32_16x16x32_bf16 v[100:103], v[68:71], v[44:47], v[100:103]
    v_mfma_f32_16x16x32_bf16 v[104:107], v[72:75], v[44:47], v[104:107]
    v_mfma_f32_16x16x32_bf16 v[108:111], v[76:79], v[44:47], v[108:111]
    v_mfma_f32_16x16x32_bf16 v[112:115], v[80:83], v[44:47], v[112:115]
    v_mfma_f32_16x16x32_bf16 v[116:119], v[84:87], v[44:47], v[116:119]
    s_waitcnt vmcnt(10)
    s_barrier
    ds_read_b128 v[40:43], v30 offset:20480
    ds_read_b64_tr_b16 v[48:49], v32 offset:20480
    ds_read_b64_tr_b16 v[50:51], v32 offset:21248
    ds_read_b64_tr_b16 v[52:53], v33 offset:20512
    ds_read_b64_tr_b16 v[54:55], v33 offset:21280
    ds_read_b64_tr_b16 v[56:57], v32 offset:20544
    ds_read_b64_tr_b16 v[58:59], v32 offset:21312
    ds_read_b64_tr_b16 v[60:61], v33 offset:20576
    ds_read_b64_tr_b16 v[62:63], v33 offset:21344
    ds_read_b64_tr_b16 v[64:65], v32 offset:20608
    ds_read_b64_tr_b16 v[66:67], v32 offset:21376
    ds_read_b128 v[44:47], v31 offset:20480
    ds_read_b64_tr_b16 v[68:69], v32 offset:26624
    ds_read_b64_tr_b16 v[70:71], v32 offset:27392
    ds_read_b64_tr_b16 v[72:73], v33 offset:26656
    ds_read_b64_tr_b16 v[74:75], v33 offset:27424
    ds_read_b64_tr_b16 v[76:77], v32 offset:26688
    ds_read_b64_tr_b16 v[78:79], v32 offset:27456
    ds_read_b64_tr_b16 v[80:81], v33 offset:26720
    ds_read_b64_tr_b16 v[82:83], v33 offset:27488
    ds_read_b64_tr_b16 v[84:85], v32 offset:26752
    ds_read_b64_tr_b16 v[86:87], v32 offset:27520
    s_waitcnt lgkmcnt(11)
    v_mfma_f32_16x16x32_bf16 v[100:103], v[48:51], v[40:43], v[100:103]
    v_mfma_f32_16x16x32_bf16 v[104:107], v[52:55], v[40:43], v[104:107]
    v_mfma_f32_16x16x32_bf16 v[108:111], v[56:59], v[40:43], v[108:111]
    v_mfma_f32_16x16x32_bf16 v[112:115], v[60:63], v[40:43], v[112:115]
    v_mfma_f32_16x16x32_bf16 v[116:119], v[64:67], v[40:43], v[116:119]
    s_waitcnt lgkmcnt(0)
    v_mfma_f32_16x16x32_bf16 v[100:103], v[68:71], v[44:47], v[100:103]
    v_mfma_f32_16x16x32_bf16 v[104:107], v[72:75], v[44:47], v[104:107]
    v_mfma_f32_16x16x32_bf16 v[108:111], v[76:79], v[44:47], v[108:111]
    v_mfma_f32_16x16x32_bf16 v[112:115], v[80:83], v[44:47], v[112:115]
    v_mfma_f32_16x16x32_bf16 v[116:119], v[84:87], v[44:47], v[116:119]
    s_waitcnt vmcnt(5)
    s_barrier
    ds_read_b128 v[40:43], v30 offset:40960
    ds_read_b64_tr_b16 v[48:49], v32 offset:40960
    ds_read_b64_tr_b16 v[50:51], v32 offset:41728
    ds_read_b64_tr_b16 v[52:53], v33 offset:40992
    ds_read_b64_tr_b16 v[54:55], v33 offset:41760
    ds_read_b64_tr_b16 v[56:57], v32 offset:41024
    ds_read_b64_tr_b16 v[58:59], v32 offset:41792
    ds_read_b64_tr_b16 v[60:61], v33 offset:41056
    ds_read_b64_tr_b16 v[62:63], v33 offset:41824
    ds_read_b64_tr_b16 v[64:65], v32 offset:41088
    ds_read_b64_tr_b16 v[66:67], v32 offset:41856
    ds_read_b128 v[44:47], v31 offset:40960
    ds_read_b64_tr_b16 v[68:69], v32 offset:47104
    ds_read_b64_tr_b16 v[70:71], v32 offset:47872
    ds_read_b64_tr_b16 v[72:73], v33 offset:47136
    ds_read_b64_tr_b16 v[74:75], v33 offset:47904
    ds_read_b64_tr_b16 v[76:77], v32 offset:47168
    ds_read_b64_tr_b16 v[78:79], v32 offset:47936
    ds_read_b64_tr_b16 v[80:81], v33 offset:47200
    ds_read_b64_tr_b16 v[82:83], v33 offset:47968
    ds_read_b64_tr_b16 v[84:85], v32 offset:47232
    ds_read_b64_tr_b16 v[86:87], v32 offset:48000
    s_waitcnt lgkmcnt(11)
    v_mfma_f32_16x16x32_bf16 v[100:103], v[48:51], v[40:43], v[100:103]
    v_mfma_f32_16x16x32_bf16 v[104:107], v[52:55], v[40:43], v[104:107]
    v_mfma_f32_16x16x32_bf16 v[108:111], v[56:59], v[40:43], v[108:111]
    v_mfma_f32_16x16x32_bf16 v[112:115], v[60:63], v[40:43], v[112:115]
    v_mfma_f32_16x16x32_bf16 v[116:119], v[64:67], v[40:43], v[116:119]
    s_waitcnt lgkmcnt(0)
    v_mfma_f32_16x16x32_bf16 v[100:103], v[68:71], v[44:47], v[100:103]
    v_mfma_f32_16x16x32_bf16 v[104:107], v[72:75], v[44:47], v[104:107]
    v_mfma_f32_16x16x32_bf16 v[108:111], v[76:79], v[44:47], v[108:111]
    v_mfma_f32_16x16x32_bf16 v[112:115], v[80:83], v[44:47], v[112:115]
    v_mfma_f32_16x16x32_bf16 v[116:119], v[84:87], v[44:47], v[116:119]
    s_waitcnt vmcnt(0)
    s_barrier
    ds_read_b128 v[40:43], v10 offset:0
    ds_read_b64_tr_b16 v[48:49], v12 offset:0
    ds_read_b64_tr_b16 v[50:51], v12 offset:768
    ds_read_b64_tr_b16 v[52:53], v13 offset:32
    ds_read_b64_tr_b16 v[54:55], v13 offset:800
    ds_read_b64_tr_b16 v[56:57], v12 offset:64
    ds_read_b64_tr_b16 v[58:59], v12 offset:832
    ds_read_b64_tr_b16 v[60:61], v13 offset:96
    ds_read_b64_tr_b16 v[62:63], v13 offset:864
    ds_read_b64_tr_b16 v[64:65], v12 offset:128
    ds_read_b64_tr_b16 v[66:67], v12 offset:896
    ds_read_b128 v[44:47], v11 offset:0
    ds_read_b64_tr_b16 v[68:69], v12 offset:6144
    ds_read_b64_tr_b16 v[70:71], v12 offset:6912
    ds_read_b64_tr_b16 v[72:73], v13 offset:6176
    ds_read_b64_tr_b16 v[74:75], v13 offset:6944
    ds_read_b64_tr_b16 v[76:77], v12 offset:6208
    ds_read_b64_tr_b16 v[78:79], v12 offset:6976
    ds_read_b64_tr_b16 v[80:81], v13 offset:6240
    ds_read_b64_tr_b16 v[82:83], v13 offset:7008
    ds_read_b64_tr_b16 v[84:85], v12 offset:6272
    ds_read_b64_tr_b16 v[86:87], v12 offset:7040
    s_waitcnt lgkmcnt(11)
    v_mfma_f32_16x16x32_bf16 v[100:103], v[48:51], v[40:43], v[100:103]
    v_mfma_f32_16x16x32_bf16 v[104:107], v[52:55], v[40:43], v[104:107]
    v_mfma_f32_16x16x32_bf16 v[108:111], v[56:59], v[40:43], v[108:111]
    v_mfma_f32_16x16x32_bf16 v[112:115], v[60:63], v[40:43], v[112:115]
    v_mfma_f32_16x16x32_bf16 v[116:119], v[64:67], v[40:43], v[116:119]
    s_waitcnt lgkmcnt(0)
    v_mfma_f32_16x16x32_bf16 v[100:103], v[68:71], v[44:47], v[100:103]
    v_mfma_f32_16x16x32_bf16 v[104:107], v[72:75], v[44:47], v[104:107]
    v_mfma_f32_16x16x32_bf16 v[108:111], v[76:79], v[44:47], v[108:111]
    v_mfma_f32_16x16x32_bf16 v[112:115], v[80:83], v[44:47], v[112:115]
    v_mfma_f32_16x16x32_bf16 v[116:119], v[84:87], v[44:47], v[116:119]
    s_nop 15
    s_mov_b32 s40, s10
    s_and_b32 s41, s11, 0xffff
    s_mov_b32 s42, 2621440
    s_mov_b32 s43, 0x20000
    s_mov_b32 s44, s56
    s_and_b32 s45, s57, 0xffff
    s_mov_b32 s46, 2621440
    s_mov_b32 s47, 0x20000
    v_and_b32 v14, 15, v2
    v_add_u32 v14, s35, v14
    v_mul_u32_u24 v14, 0x500, v14
    v_lshrrev_b32 v15, 4, v2
    v_lshl_add_u32 v14, v15, 3, v14
    buffer_load_dwordx2 v[20:21], v14, s[40:43], s60 offen offset:0
    buffer_load_dwordx2 v[22:23], v14, s[40:43], s60 offen offset:32
    buffer_load_dwordx2 v[24:25], v14, s[40:43], s60 offen offset:64
    buffer_load_dwordx2 v[26:27], v14, s[40:43], s60 offen offset:96
    buffer_load_dwordx2 v[28:29], v14, s[40:43], s60 offen offset:128
    s_waitcnt vmcnt(0)
    v_lshlrev_b32 v30, 16, v20
    v_and_b32 v31, 0xffff0000, v20
    v_add_f32 v100, v100, v30
    v_add_f32 v101, v101, v31
    v_lshlrev_b32 v30, 16, v21
    v_and_b32 v31, 0xffff0000, v21
    v_add_f32 v102, v102, v30
    v_add_f32 v103, v103, v31
    v_cvt_pk_bf16_f32 v20, v100, v101
    v_cvt_pk_bf16_f32 v21, v102, v103
    v_lshlrev_b32 v30, 16, v22
    v_and_b32 v31, 0xffff0000, v22
    v_add_f32 v104, v104, v30
    v_add_f32 v105, v105, v31
    v_lshlrev_b32 v30, 16, v23
    v_and_b32 v31, 0xffff0000, v23
    v_add_f32 v106, v106, v30
    v_add_f32 v107, v107, v31
    v_cvt_pk_bf16_f32 v22, v104, v105
    v_cvt_pk_bf16_f32 v23, v106, v107
    v_lshlrev_b32 v30, 16, v24
    v_and_b32 v31, 0xffff0000, v24
    v_add_f32 v108, v108, v30
    v_add_f32 v109, v109, v31
    v_lshlrev_b32 v30, 16, v25
    v_and_b32 v31, 0xffff0000, v25
    v_add_f32 v110, v110, v30
    v_add_f32 v111, v111, v31
    v_cvt_pk_bf16_f32 v24, v108, v109
    v_cvt_pk_bf16_f32 v25, v110, v111
    v_lshlrev_b32 v30, 16, v26
    v_and_b32 v31, 0xffff0000, v26
    v_add_f32 v112, v112, v30
    v_add_f32 v113, v113, v31
    v_lshlrev_b32 v30, 16, v27
    v_and_b32 v31, 0xffff0000, v27
    v_add_f32 v114, v114, v30
    v_add_f32 v115, v115, v31
    v_cvt_pk_bf16_f32 v26, v112, v113
    v_cvt_pk_bf16_f32 v27, v114, v115
    v_lshlrev_b32 v30, 16, v28
    v_and_b32 v31, 0xffff0000, v28
    v_add_f32 v116, v116, v30
    v_add_f32 v117, v117, v31
    v_lshlrev_b32 v30, 16, v29
    v_and_b32 v31, 0xffff0000, v29
    v_add_f32 v118, v118, v30
    v_add_f32 v119, v119, v31
    v_cvt_pk_bf16_f32 v28, v116, v117
    v_cvt_pk_bf16_f32 v29, v118, v119
    buffer_store_dwordx2 v[20:21], v14, s[44:47], s60 offen offset:0
    buffer_store_dwordx2 v[22:23], v14, s[44:47], s60 offen offset:32
    buffer_store_dwordx2 v[24:25], v14, s[44:47], s60 offen offset:64
    buffer_store_dwordx2 v[26:27], v14, s[44:47], s60 offen offset:96
    buffer_store_dwordx2 v[28:29], v14, s[44:47], s60 offen offset:128
    s_waitcnt vmcnt(0)
g2_done:
    s_endpgm
.section .rodata,"a"
.p2align 6
.p2align 6
.amdhsa_kernel ln_kernel
  .amdhsa_next_free_vgpr 48
  .amdhsa_next_free_sgpr 100
  .amdhsa_accum_offset 48
  .amdhsa_group_segment_fixed_size 0
  .amdhsa_kernarg_size 80
  .amdhsa_user_sgpr_count 2
  .amdhsa_user_sgpr_kernarg_segment_ptr 1
  .amdhsa_system_sgpr_workgroup_id_x 1
.end_amdhsa_kernel
.p2align 6
.amdhsa_kernel gemm1_kernel
  .amdhsa_next_free_vgpr 200
  .amdhsa_next_free_sgpr 100
  .amdhsa_accum_offset 200
  .amdhsa_group_segment_fixed_size 0
  .amdhsa_kernarg_size 80
  .amdhsa_user_sgpr_count 2
  .amdhsa_user_sgpr_kernarg_segment_ptr 1
  .amdhsa_system_sgpr_workgroup_id_x 1
.end_amdhsa_kernel
.p2align 6
.amdhsa_kernel attn_kernel
  .amdhsa_next_free_vgpr 232
  .amdhsa_next_free_sgpr 100
  .amdhsa_accum_offset 232
  .amdhsa_group_segment_fixed_size 0
  .amdhsa_kernarg_size 80
  .amdhsa_user_sgpr_count 2
  .amdhsa_user_sgpr_kernarg_segment_ptr 1
  .amdhsa_system_sgpr_workgroup_id_x 1
.end_amdhsa_kernel
.p2align 6
.amdhsa_kernel gemm2_kernel
  .amdhsa_next_free_vgpr 128
  .amdhsa_next_free_sgpr 100
  .amdhsa_accum_offset 128
  .amdhsa_group_segment_fixed_size 0
  .amdhsa_kernarg_size 80
  .amdhsa_user_sgpr_count 2
  .amdhsa_user_sgpr_kernarg_segment_ptr 1
  .amdhsa_system_sgpr_workgroup_id_x 1
.end_amdhsa_kernel
```
